```python
import torch

def _softmax(x, axis=-1):
    return torch.softmax(x, dim=axis)
def _gelu(x):
    return torch.nn.functional.gelu(x, approximate="tanh")
def _silu(x):
    return torch.nn.functional.silu(x)
def _sigmoid(x):
    return torch.sigmoid(x)
def _layernorm(x, axis=-1, eps=1e-5):
    m = x.mean(dim=axis, keepdim=True)
    v = x.var(dim=axis, keepdim=True, unbiased=False)
    return (x - m) / torch.sqrt(v + eps)
def _scatter_add(tgt, idx, src, axis=0):
    return tgt.clone().index_add_(axis, idx, src)
def _segment_sum(src, seg, n):
    out = torch.zeros((n,) + src.shape[1:], dtype=src.dtype)
    return out.index_add_(0, seg, src)
def _pad(x, pw):
    flat = tuple(v for pair in reversed(pw) for v in pair)
    return torch.nn.functional.pad(x, flat)

kernel_name = 'gated_mix__softmax_full_mha__mha_block__prompt'

def setup_inputs():

    _w = (lambda a: (lambda t: t.to(torch.bfloat16) if t.is_floating_point() else t)(torch.as_tensor(a)))
    def _A_setup():
        B, S, D = 1, 2048, 448
        return {
            "x": _w((lambda *s: torch.randn(*s, dtype=torch.bfloat16) * 0.05)(B, S, D)),
            "wqkv": _w((lambda *s: torch.randn(*s, dtype=torch.bfloat16) * 0.8)(D, 3 * D)),
            "wo": _w((lambda *s: torch.randn(*s, dtype=torch.bfloat16) * 0.05)(D, D)),
        }
    _A_in = _A_setup()

    def _B_setup():
        B, S, D, H = 1, 2048, 448, 16
        return {
            "x": _w((lambda *s: torch.randn(*s, dtype=torch.bfloat16) * 0.05)(B, S, D)),
            "wqkv": _w((lambda *s: torch.randn(*s, dtype=torch.bfloat16) * 0.8)(D, 3 * D)),
            "wo": _w((lambda *s: torch.randn(*s, dtype=torch.bfloat16) * 0.05)(D, D)),
        }
    _B_in = _B_setup()

    return {
        "A_x": _A_in["x"],
        "A_wqkv": _A_in["wqkv"],
        "A_wo": _A_in["wo"],
        "B_x": _B_in["x"],
        "B_wqkv": _B_in["wqkv"],
        "B_wo": _B_in["wo"],
        "gate_w": _w((lambda *s: torch.randn(*s, dtype=torch.bfloat16) * 0.05)(448) * 16.0),
    }

def reference(A_x, A_wqkv, A_wo, B_x, B_wqkv, B_wo, gate_w):
    def _A_ref(x, wqkv, wo):
        B, S, D = x.shape
        H = 16; Dh = D // H
        qkv = (lambda x, *d: x.permute(*d))((x @ wqkv).reshape(B, S, 3, H, Dh), 2, 0, 3, 1, 4)
        q, k, v = qkv[0], qkv[1], qkv[2]
        scale = Dh ** -0.5
        scores = torch.einsum("bhqd,bhkd->bhqk", q, k) * scale
        p = _softmax(scores, axis=-1)
        o = torch.einsum("bhqk,bhkd->bhqd", p, v)
        return (lambda x, *d: x.permute(*d))(o, 0, 2, 1, 3).reshape(B, S, D) @ wo

    def _B_ref(x, wqkv, wo):
        B, S, D = x.shape
        H = 16
        Dh = D // H
        qkv = (lambda x, *d: x.permute(*d))((x @ wqkv).reshape(B, S, 3, H, Dh), 2, 0, 3, 1, 4)
        q, k, v = qkv[0], qkv[1], qkv[2]
        scores = torch.einsum("bhqd,bhkd->bhqk", q, k) * (Dh ** -0.5)
        p = _softmax(scores, axis=-1)
        o = torch.einsum("bhqk,bhkd->bhqd", p, v)
        return (lambda x, *d: x.permute(*d))(o, 0, 2, 1, 3).reshape(B, S, D) @ wo

    x = A_x
    g = _sigmoid((x * gate_w).sum(-1, keepdims=True))
    a = _A_ref(x, A_wqkv, A_wo)
    b = _B_ref(x, B_wqkv, B_wo)
    return g * a + (1 - g) * b
```

```asm
; @launch grid=(256,1,1) block=(512,1,1) lds=163840
.amdgcn_target "amdgcn-amd-amdhsa--gfx950"
.text
.globl gated_mix__softmax_full_mha__mha_block__prompt_kernel
.p2align 8
.type gated_mix__softmax_full_mha__mha_block__prompt_kernel,@function
gated_mix__softmax_full_mha__mha_block__prompt_kernel:
    s_cmp_ge_u32 s2, 256
    s_cbranch_scc1 L_end
    s_load_dwordx16 s[4:19], s[0:1], 0
    s_load_dwordx2 s[20:21], s[0:1], 72
    v_lshrrev_b32 v1, 6, v0
    v_and_b32 v2, 63, v0
    s_and_b32 s22, s2, 7
    s_lshr_b32 s23, s2, 3
    v_readfirstlane_b32 s52, v1
    s_lshl_b32 s55, s22, 1
    s_and_b32 s22, s23, 1
    s_add_u32 s55, s55, s22
    s_lshr_b32 s56, s23, 1
    s_and_b32 s22, s55, 7
    s_mul_i32 s58, s22, 3
    s_mul_i32 s23, s56, 1
    s_add_u32 s58, s58, s23
    s_mul_i32 s23, s58, 9363
    s_lshr_b32 s23, s23, 16
    s_mul_i32 s23, s23, 7
    s_sub_u32 s58, s58, s23
    s_sub_u32 s23, s22, 1
    s_mul_i32 s60, s22, 112
    s_cmp_lt_u32 s23, 3
    s_cselect_b32 s44, 48, 0
    s_and_b32 s53, s52, 3
    s_lshr_b32 s54, s52, 2
    s_mul_i32 s23, s53, 43008
    s_add_u32 s49, s60, s23
    s_mul_i32 s23, s54, 896
    s_add_u32 s45, s49, s23
    s_add_u32 s60, s45, 896
    v_lshrrev_b32 v11, 3, v2
    v_and_b32 v12, 7, v2
    v_lshrrev_b32 v13, 4, v2
    v_xor_b32 v14, v12, v13
    s_lshl_b32 s22, s56, 7
    s_lshl_b32 s23, s52, 4
    s_add_u32 s22, s22, s23
    v_add_u32 v1, s22, v11
    v_mul_u32_u24 v1, 896, v1
    v_lshl_add_u32 v8, v14, 4, v1
    v_xor_b32 v14, 4, v14
    v_lshl_add_u32 v9, v14, 4, v1
    v_add_u32 v9, 6144, v9
    s_lshl_b32 s59, s52, 12
    v_lshrrev_b32 v1, 2, v2
    v_and_b32 v10, 3, v2
    v_mul_u32_u24 v1, 2688, v1
    s_xor_b32 s22, s44, 48
    v_lshl_add_u32 v207, v10, 4, s22
    v_lshl_add_u32 v10, v10, 4, v1
    v_add_u32 v207, v207, v1
    v_add_u32 v10, s44, v10
    s_cmp_lt_u32 s55, 8
    s_waitcnt lgkmcnt(0)
    s_mov_b32 s24, s4
    s_mov_b32 s25, s5
    s_mov_b32 s26, 1835008
    s_mov_b32 s27, 0x00020000
    s_cselect_b32 s28, s6, s12
    s_cselect_b32 s29, s7, s13
    s_mov_b32 s30, 1204224
    s_mov_b32 s31, 0x00020000
    s_mov_b32 s3, s58
    s_add_u32 m0, s59, 0
    s_lshl_b32 s61, s58, 7
    s_mul_i32 s62, s58, 172032
    buffer_load_dwordx4 v8, s[24:27], s61 offen lds
    s_add_u32 s62, s62, s60
    buffer_load_dwordx4 v9, s[24:27], s61 offen offset:1024 lds
    s_add_u32 m0, m0, 2048
    s_add_u32 s58, s58, 1
    buffer_load_dwordx4 v10, s[28:31], s62 offen lds
    s_add_u32 m0, m0, 1024
    s_cmp_eq_u32 s58, 7
    s_cselect_b32 s58, 0, s58
    buffer_load_dwordx4 v207, s[28:31], s62 offen  lds
    s_barrier
    s_add_u32 m0, s59, 32768
    s_lshl_b32 s61, s58, 7
    s_mul_i32 s62, s58, 172032
    buffer_load_dwordx4 v8, s[24:27], s61 offen lds
    s_add_u32 s62, s62, s60
    buffer_load_dwordx4 v9, s[24:27], s61 offen offset:1024 lds
    s_add_u32 m0, m0, 2048
    s_add_u32 s58, s58, 1
    buffer_load_dwordx4 v10, s[28:31], s62 offen lds
    s_add_u32 m0, m0, 1024
    s_cmp_eq_u32 s58, 7
    s_cselect_b32 s58, 0, s58
    buffer_load_dwordx4 v207, s[28:31], s62 offen  lds
    s_mov_b32 s36, s20
    s_mov_b32 s37, s21
    s_mov_b32 s38, 13631488
    s_mov_b32 s39, 0x00020000
    s_mov_b32 s61, 13107212
    s_lshl_b32 s57, s55, 1
    s_add_u32 s57, s57, s54
    buffer_load_dword v5, off, s[36:39], s61 sc1
    s_lshl_b32 s61, s57, 18
    s_add_u32 s32, s20, s61
    s_addc_u32 s33, s21, 0
    s_mov_b32 s34, 262144
    s_mov_b32 s35, 0x00020000
    s_lshl_b32 s64, s56, 2
    s_add_u32 s64, s64, s53
    s_lshl_b32 s64, s64, 12
    s_lshl_b32 s70, s57, 2
    s_add_u32 s70, s70, s53
    s_lshl_b32 s70, s70, 7
    s_add_u32 s70, s70, 12582912
    v_and_b32 v205, 15, v2
    s_add_u32 s71, s70, 65536
    v_lshlrev_b32 v205, 2, v205
    s_getreg_b32 s67, hwreg(HW_REG_XCC_ID, 0, 4)
    buffer_load_dword v7, off, s[36:39], s71 sc1
    buffer_load_dword v7, off, s[36:39], s70 sc1
    s_mov_b32 s50, 0x0fffffff
    s_mov_b32 s51, 0x0fffffff
    v_lshlrev_b32 v3, 4, v2
    v_mov_b32 v4, 0xdddddddd
    s_lshl_b32 s61, s52, 8
    s_add_u32 s61, s61, 155648
    v_lshl_add_u32 v252, v2, 2, s61
    v_mov_b32 v251, 0
    v_and_b32 v15, 3, v2
    ds_write_b32 v252, v251
    s_lshl_b32 s61, s54, 10
    s_add_u32 s61, s61, 155648
    v_mul_u32_u24 v253, 260, v15
    v_add_u32 v253, s61, v253
    v_xor_b32 v254, 1024, v253
    v_lshrrev_b32 v250, 5, v2
    v_bfe_u32 v12, v2, 1, 3
    v_xor_b32 v12, v250, v12
    v_and_b32 v13, 15, v2
    v_lshlrev_b32 v13, 7, v13
    v_lshl_add_u32 v12, v12, 4, v13
    v_bfe_u32 v13, v2, 4, 1
    v_lshlrev_b32 v14, 12, v13
    s_lshl_b32 s61, s53, 13
    v_add3_u32 v11, v12, v14, s61
    v_xor_b32 v12, 32, v11
    v_xor_b32 v14, 96, v11
    v_lshlrev_b32 v15, 3, v15
    v_lshl_add_u32 v15, v13, 5, v15
    v_xor_b32 v13, 64, v11
    v_add_u32 v249, 8, v15
    v_and_b32 v249, 63, v249
    v_bfe_u32 v247, v2, 2, 2
    v_lshl_add_u32 v247, v250, 3, v247
    v_lshl_add_u32 v15, v247, 6, v15
    v_lshl_add_u32 v249, v247, 6, v249
    s_lshr_b32 s62, s44, 5
    s_xor_b32 s62, s62, s54
    s_cselect_b64 vcc, -1, 0
    s_cselect_b32 s63, 0, 56
    v_cndmask_b32 v249, v15, v249, vcc
    s_lshl_b32 s61, s54, 10
    s_add_u32 s61, s61, 2048
    v_add_u32 v15, s61, v249
    s_mul_i32 s61, s54, 28672
    s_add_u32 s61, s61, 98304
    v_add_u32 v248, s61, v249
    s_mov_b32 s40, s16
    s_mov_b32 s41, s17
    s_mov_b32 s42, 896
    s_mov_b32 s43, 0x00020000
    v_lshrrev_b32 v1, 4, v2
    v_add_u32 v200, s3, v1
    v_subrev_u32 v201, 7, v200
    v_add_u32 v202, 4, v200
    v_min_u32 v200, v200, v201
    v_subrev_u32 v201, 7, v202
    v_and_b32 v203, 15, v2
    v_min_u32 v202, v202, v201
    v_lshlrev_b32 v201, 1, v203
    s_lshl_b32 s62, s53, 5
    v_lshl_add_u32 v200, v200, 7, v201
    v_lshl_add_u32 v202, v202, 7, v201
    buffer_load_ushort v200, v200, s[40:43], s62 offen
    buffer_load_ushort v202, v202, s[40:43], s62 offen
    s_lshl_b32 s57, s53, 10
    s_add_u32 s61, s61, s57
    s_add_u32 s61, s61, s63
    v_lshlrev_b32 v1, 12, v1
    v_lshl_add_u32 v1, v203, 6, v1
    v_add_u32 v204, s61, v1
    v_mov_b32 v201, 0
    v_mov_b32 v203, 0
    s_mul_i32 s61, s3, 172032
    s_add_u32 s45, s49, s61
    s_mov_b32 s48, 32768
    s_mov_b32 s61, 126976
    s_cmp_eq_u32 s54, 0
    s_cselect_b64 vcc, -1, 0
    s_cselect_b32 s61, 98304, s61
    s_cselect_b32 s48, 90112, s48
    s_cselect_b32 s65, 13, 18
    s_add_u32 s57, s57, s61
    v_cndmask_b32 v206, v207, v10, vcc
    v_mov_b32 v208, 0x3f803f80
    v_mov_b32 v209, 0x3f803f80
    v_mov_b32 v210, 0x3f803f80
    v_mov_b32 v211, 0x3f803f80
    v_mov_b32 v212, 0x3f803f80
    v_mov_b32 v213, 0x3f803f80
    v_mov_b32 v214, 0x3f803f80
    v_mov_b32 v215, 0x3f803f80
    s_waitcnt vmcnt(9) lgkmcnt(0)
    s_barrier
    ds_read_b128 v[16:19], v11 offset:0
    ds_read_b64_tr_b16 v[128:129], v15 offset:0
    ds_read_b64_tr_b16 v[130:131], v15 offset:256
    ds_read_b64_tr_b16 v[132:133], v15 offset:16384
    ds_read_b64_tr_b16 v[134:135], v15 offset:16640
    ds_read_b128 v[20:23], v12 offset:0
    ds_read_b64_tr_b16 v[136:137], v15 offset:4096
    ds_read_b64_tr_b16 v[138:139], v15 offset:4352
    ds_read_b64_tr_b16 v[140:141], v15 offset:20480
    ds_read_b64_tr_b16 v[142:143], v15 offset:20736
    s_add_u32 m0, s59, 65536
    s_lshl_b32 s61, s58, 7
    s_mul_i32 s62, s58, 172032
    buffer_load_dwordx4 v8, s[24:27], s61 offen lds
    s_add_u32 s62, s62, s60
    buffer_load_dwordx4 v9, s[24:27], s61 offen offset:1024 lds
    s_add_u32 m0, m0, 2048
    s_add_u32 s58, s58, 1
    buffer_load_dwordx4 v10, s[28:31], s62 offen lds
    s_add_u32 m0, m0, 1024
    s_cmp_eq_u32 s58, 7
    s_cselect_b32 s58, 0, s58
    buffer_load_dwordx4 v207, s[28:31], s62 offen  lds
    s_waitcnt lgkmcnt(5)
    v_mfma_f32_32x32x16_bf16 v[184:199], v[128:131], v[16:19], 0
    v_mfma_f32_32x32x16_bf16 v[216:231], v[16:19], v[132:135], 0
    ds_read_b128 v[24:27], v13 offset:0
    ds_read_b64_tr_b16 v[144:145], v15 offset:8192
    ds_read_b64_tr_b16 v[146:147], v15 offset:8448
    ds_read_b64_tr_b16 v[148:149], v15 offset:24576
    ds_read_b64_tr_b16 v[150:151], v15 offset:24832
    s_waitcnt lgkmcnt(5)
    v_mfma_f32_32x32x16_bf16 v[184:199], v[136:139], v[20:23], v[184:199]
    v_mfma_f32_32x32x16_bf16 v[216:231], v[20:23], v[140:143], v[216:231]
    ds_read_b128 v[28:31], v14 offset:0
    ds_read_b64_tr_b16 v[152:153], v15 offset:12288
    ds_read_b64_tr_b16 v[154:155], v15 offset:12544
    ds_read_b64_tr_b16 v[156:157], v15 offset:28672
    ds_read_b64_tr_b16 v[158:159], v15 offset:28928
    s_waitcnt lgkmcnt(5)
    v_mfma_f32_32x32x16_bf16 v[184:199], v[144:147], v[24:27], v[184:199]
    v_mfma_f32_32x32x16_bf16 v[216:231], v[24:27], v[148:151], v[216:231]
    s_waitcnt lgkmcnt(0)
    v_mfma_f32_32x32x16_bf16 v[184:199], v[152:155], v[28:31], v[184:199]
    v_mfma_f32_32x32x16_bf16 v[216:231], v[28:31], v[156:159], v[216:231]
    s_waitcnt vmcnt(9) lgkmcnt(0)
    s_barrier
    ds_read_b128 v[32:35], v11 offset:32768
    ds_read_b64_tr_b16 v[128:129], v15 offset:32768
    ds_read_b64_tr_b16 v[130:131], v15 offset:33024
    ds_read_b64_tr_b16 v[132:133], v15 offset:49152
    ds_read_b64_tr_b16 v[134:135], v15 offset:49408
    ds_read_b128 v[36:39], v12 offset:32768
    ds_read_b64_tr_b16 v[136:137], v15 offset:36864
    ds_read_b64_tr_b16 v[138:139], v15 offset:37120
    ds_read_b64_tr_b16 v[140:141], v15 offset:53248
    ds_read_b64_tr_b16 v[142:143], v15 offset:53504
    s_add_u32 m0, s59, 0
    s_lshl_b32 s61, s58, 7
    s_mul_i32 s62, s58, 172032
    buffer_load_dwordx4 v8, s[24:27], s61 offen lds
    s_add_u32 s62, s62, s60
    buffer_load_dwordx4 v9, s[24:27], s61 offen offset:1024 lds
    s_add_u32 m0, m0, 2048
    s_add_u32 s58, s58, 1
    buffer_load_dwordx4 v10, s[28:31], s62 offen lds
    s_add_u32 m0, m0, 1024
    s_cmp_eq_u32 s58, 7
    s_cselect_b32 s58, 0, s58
    buffer_load_dwordx4 v207, s[28:31], s62 offen  lds
    s_waitcnt lgkmcnt(5)
    v_mfma_f32_32x32x16_bf16 v[184:199], v[128:131], v[32:35], v[184:199]
    v_mfma_f32_32x32x16_bf16 v[216:231], v[32:35], v[132:135], v[216:231]
    ds_read_b128 v[40:43], v13 offset:32768
    ds_read_b64_tr_b16 v[144:145], v15 offset:40960
    ds_read_b64_tr_b16 v[146:147], v15 offset:41216
    ds_read_b64_tr_b16 v[148:149], v15 offset:57344
    ds_read_b64_tr_b16 v[150:151], v15 offset:57600
    s_waitcnt lgkmcnt(5)
    v_mfma_f32_32x32x16_bf16 v[184:199], v[136:139], v[36:39], v[184:199]
    v_mfma_f32_32x32x16_bf16 v[216:231], v[36:39], v[140:143], v[216:231]
    ds_read_b128 v[44:47], v14 offset:32768
    ds_read_b64_tr_b16 v[152:153], v15 offset:45056
    ds_read_b64_tr_b16 v[154:155], v15 offset:45312
    ds_read_b64_tr_b16 v[156:157], v15 offset:61440
    ds_read_b64_tr_b16 v[158:159], v15 offset:61696
    s_waitcnt lgkmcnt(5)
    v_mfma_f32_32x32x16_bf16 v[184:199], v[144:147], v[40:43], v[184:199]
    v_mfma_f32_32x32x16_bf16 v[216:231], v[40:43], v[148:151], v[216:231]
    s_waitcnt lgkmcnt(0)
    v_mfma_f32_32x32x16_bf16 v[184:199], v[152:155], v[44:47], v[184:199]
    v_mfma_f32_32x32x16_bf16 v[216:231], v[44:47], v[156:159], v[216:231]
    v_add_u32 v11, 65536, v11
    v_add_u32 v12, 65536, v12
    v_add_u32 v13, 65536, v13
    v_add_u32 v14, 65536, v14
    v_add_u32 v15, 65536, v15
    s_waitcnt vmcnt(4) lgkmcnt(0)
    s_barrier
    v_add_u32 v5, 2654435769, v5
    v_and_b32 v5, 0x3fffffff, v5
    s_lshl_b32 s61, s56, 2
    v_xor_b32 v6, s67, v5
    s_add_u32 s61, s61, s71
    s_mov_b64 exec, 1
    buffer_store_dword v6, off, s[36:39], s61
    s_mov_b64 exec, -1
    ds_read_b128 v[48:51], v11 offset:0
    ds_read_b64_tr_b16 v[128:129], v15 offset:0
    ds_read_b64_tr_b16 v[130:131], v15 offset:256
    ds_read_b64_tr_b16 v[132:133], v15 offset:16384
    ds_read_b64_tr_b16 v[134:135], v15 offset:16640
    ds_read_b128 v[52:55], v12 offset:0
    ds_read_b64_tr_b16 v[136:137], v15 offset:4096
    ds_read_b64_tr_b16 v[138:139], v15 offset:4352
    ds_read_b64_tr_b16 v[140:141], v15 offset:20480
    ds_read_b64_tr_b16 v[142:143], v15 offset:20736
    s_add_u32 m0, s59, 32768
    s_lshl_b32 s61, s58, 7
    s_mul_i32 s62, s58, 172032
    buffer_load_dwordx4 v8, s[24:27], s61 offen lds
    s_add_u32 s62, s62, s60
    buffer_load_dwordx4 v9, s[24:27], s61 offen offset:1024 lds
    s_add_u32 m0, m0, 2048
    s_add_u32 s58, s58, 1
    buffer_load_dwordx4 v10, s[28:31], s62 offen lds
    s_add_u32 m0, m0, 1024
    s_cmp_eq_u32 s58, 7
    s_cselect_b32 s58, 0, s58
    buffer_load_dwordx4 v207, s[28:31], s62 offen  lds
    s_waitcnt lgkmcnt(5)
    v_mfma_f32_32x32x16_bf16 v[184:199], v[128:131], v[48:51], v[184:199]
    v_mfma_f32_32x32x16_bf16 v[216:231], v[48:51], v[132:135], v[216:231]
    ds_read_b128 v[56:59], v13 offset:0
    ds_read_b64_tr_b16 v[144:145], v15 offset:8192
    ds_read_b64_tr_b16 v[146:147], v15 offset:8448
    ds_read_b64_tr_b16 v[148:149], v15 offset:24576
    ds_read_b64_tr_b16 v[150:151], v15 offset:24832
    s_waitcnt lgkmcnt(5)
    v_mfma_f32_32x32x16_bf16 v[184:199], v[136:139], v[52:55], v[184:199]
    v_mfma_f32_32x32x16_bf16 v[216:231], v[52:55], v[140:143], v[216:231]
    ds_read_b128 v[60:63], v14 offset:0
    ds_read_b64_tr_b16 v[152:153], v15 offset:12288
    ds_read_b64_tr_b16 v[154:155], v15 offset:12544
    ds_read_b64_tr_b16 v[156:157], v15 offset:28672
    ds_read_b64_tr_b16 v[158:159], v15 offset:28928
    s_waitcnt lgkmcnt(5)
    v_mfma_f32_32x32x16_bf16 v[184:199], v[144:147], v[56:59], v[184:199]
    v_mfma_f32_32x32x16_bf16 v[216:231], v[56:59], v[148:151], v[216:231]
    s_waitcnt lgkmcnt(0)
    v_mfma_f32_32x32x16_bf16 v[184:199], v[152:155], v[60:63], v[184:199]
    v_mfma_f32_32x32x16_bf16 v[216:231], v[60:63], v[156:159], v[216:231]
    v_add_u32 v11, 4294901760, v11
    v_add_u32 v12, 4294901760, v12
    v_add_u32 v13, 4294901760, v13
    v_add_u32 v14, 4294901760, v14
    v_add_u32 v15, 4294901760, v15
    s_waitcnt vmcnt(5) lgkmcnt(0)
    s_barrier
    ds_read_b128 v[64:67], v11 offset:0
    ds_read_b64_tr_b16 v[128:129], v15 offset:0
    ds_read_b64_tr_b16 v[130:131], v15 offset:256
    ds_read_b64_tr_b16 v[132:133], v15 offset:16384
    ds_read_b64_tr_b16 v[134:135], v15 offset:16640
    ds_read_b128 v[68:71], v12 offset:0
    ds_read_b64_tr_b16 v[136:137], v15 offset:4096
    ds_read_b64_tr_b16 v[138:139], v15 offset:4352
    ds_read_b64_tr_b16 v[140:141], v15 offset:20480
    ds_read_b64_tr_b16 v[142:143], v15 offset:20736
    s_add_u32 m0, s59, 65536
    s_lshl_b32 s61, s58, 7
    s_mul_i32 s62, s58, 172032
    buffer_load_dwordx4 v8, s[24:27], s61 offen lds
    s_add_u32 s62, s62, s60
    buffer_load_dwordx4 v9, s[24:27], s61 offen offset:1024 lds
    s_add_u32 m0, m0, 2048
    s_add_u32 s58, s58, 1
    buffer_load_dwordx4 v10, s[28:31], s62 offen lds
    s_add_u32 m0, m0, 1024
    s_cmp_eq_u32 s58, 7
    s_cselect_b32 s58, 0, s58
    buffer_load_dwordx4 v207, s[28:31], s62 offen  lds
    s_waitcnt lgkmcnt(5)
    v_mfma_f32_32x32x16_bf16 v[184:199], v[128:131], v[64:67], v[184:199]
    v_mfma_f32_32x32x16_bf16 v[216:231], v[64:67], v[132:135], v[216:231]
    ds_read_b128 v[72:75], v13 offset:0
    ds_read_b64_tr_b16 v[144:145], v15 offset:8192
    ds_read_b64_tr_b16 v[146:147], v15 offset:8448
    ds_read_b64_tr_b16 v[148:149], v15 offset:24576
    ds_read_b64_tr_b16 v[150:151], v15 offset:24832
    s_waitcnt lgkmcnt(5)
    v_mfma_f32_32x32x16_bf16 v[184:199], v[136:139], v[68:71], v[184:199]
    v_mfma_f32_32x32x16_bf16 v[216:231], v[68:71], v[140:143], v[216:231]
    ds_read_b128 v[76:79], v14 offset:0
    ds_read_b64_tr_b16 v[152:153], v15 offset:12288
    ds_read_b64_tr_b16 v[154:155], v15 offset:12544
    ds_read_b64_tr_b16 v[156:157], v15 offset:28672
    ds_read_b64_tr_b16 v[158:159], v15 offset:28928
    s_waitcnt lgkmcnt(5)
    v_mfma_f32_32x32x16_bf16 v[184:199], v[144:147], v[72:75], v[184:199]
    v_mfma_f32_32x32x16_bf16 v[216:231], v[72:75], v[148:151], v[216:231]
    s_waitcnt lgkmcnt(0)
    v_mfma_f32_32x32x16_bf16 v[184:199], v[152:155], v[76:79], v[184:199]
    v_mfma_f32_32x32x16_bf16 v[216:231], v[76:79], v[156:159], v[216:231]
    s_waitcnt vmcnt(4) lgkmcnt(0)
    s_barrier
    ds_read_b128 v[80:83], v11 offset:32768
    ds_read_b64_tr_b16 v[128:129], v15 offset:32768
    ds_read_b64_tr_b16 v[130:131], v15 offset:33024
    ds_read_b64_tr_b16 v[132:133], v15 offset:49152
    ds_read_b64_tr_b16 v[134:135], v15 offset:49408
    ds_read_b128 v[84:87], v12 offset:32768
    ds_read_b64_tr_b16 v[136:137], v15 offset:36864
    ds_read_b64_tr_b16 v[138:139], v15 offset:37120
    ds_read_b64_tr_b16 v[140:141], v15 offset:53248
    ds_read_b64_tr_b16 v[142:143], v15 offset:53504
    s_add_u32 m0, s59, 0
    s_lshl_b32 s61, s58, 7
    s_mul_i32 s62, s58, 172032
    buffer_load_dwordx4 v8, s[24:27], s61 offen lds
    s_add_u32 s62, s62, s60
    buffer_load_dwordx4 v9, s[24:27], s61 offen offset:1024 lds
    s_add_u32 m0, m0, 2048
    s_add_u32 s58, s58, 1
    buffer_load_dwordx4 v10, s[28:31], s62 offen lds
    s_add_u32 m0, m0, 1024
    s_cmp_eq_u32 s58, 7
    s_cselect_b32 s58, 0, s58
    buffer_load_dwordx4 v207, s[28:31], s62 offen  lds
    s_waitcnt lgkmcnt(5)
    v_mfma_f32_32x32x16_bf16 v[184:199], v[128:131], v[80:83], v[184:199]
    v_mfma_f32_32x32x16_bf16 v[216:231], v[80:83], v[132:135], v[216:231]
    ds_read_b128 v[88:91], v13 offset:32768
    ds_read_b64_tr_b16 v[144:145], v15 offset:40960
    ds_read_b64_tr_b16 v[146:147], v15 offset:41216
    ds_read_b64_tr_b16 v[148:149], v15 offset:57344
    ds_read_b64_tr_b16 v[150:151], v15 offset:57600
    s_waitcnt lgkmcnt(5)
    v_mfma_f32_32x32x16_bf16 v[184:199], v[136:139], v[84:87], v[184:199]
    v_mfma_f32_32x32x16_bf16 v[216:231], v[84:87], v[140:143], v[216:231]
    ds_read_b128 v[92:95], v14 offset:32768
    ds_read_b64_tr_b16 v[152:153], v15 offset:45056
    ds_read_b64_tr_b16 v[154:155], v15 offset:45312
    ds_read_b64_tr_b16 v[156:157], v15 offset:61440
    ds_read_b64_tr_b16 v[158:159], v15 offset:61696
    s_waitcnt lgkmcnt(5)
    v_mfma_f32_32x32x16_bf16 v[184:199], v[144:147], v[88:91], v[184:199]
    v_mfma_f32_32x32x16_bf16 v[216:231], v[88:91], v[148:151], v[216:231]
    s_waitcnt lgkmcnt(0)
    v_mfma_f32_32x32x16_bf16 v[184:199], v[152:155], v[92:95], v[184:199]
    v_mfma_f32_32x32x16_bf16 v[216:231], v[92:95], v[156:159], v[216:231]
    v_add_u32 v11, 65536, v11
    v_add_u32 v12, 65536, v12
    v_add_u32 v13, 65536, v13
    v_add_u32 v14, 65536, v14
    v_add_u32 v15, 65536, v15
    s_waitcnt vmcnt(4) lgkmcnt(0)
    s_barrier
    buffer_load_dword v7, v205, s[36:39], s71 offen sc1
    ds_read_b128 v[96:99], v11 offset:0
    ds_read_b64_tr_b16 v[128:129], v15 offset:0
    ds_read_b64_tr_b16 v[130:131], v15 offset:256
    ds_read_b64_tr_b16 v[132:133], v15 offset:16384
    ds_read_b64_tr_b16 v[134:135], v15 offset:16640
    ds_read_b128 v[100:103], v12 offset:0
    ds_read_b64_tr_b16 v[136:137], v15 offset:4096
    ds_read_b64_tr_b16 v[138:139], v15 offset:4352
    ds_read_b64_tr_b16 v[140:141], v15 offset:20480
    ds_read_b64_tr_b16 v[142:143], v15 offset:20736
    s_add_u32 m0, s57, 0
    s_add_u32 s61, s45, 172032
    buffer_load_dwordx4 v206, s[28:31], s45 offen lds
    s_sub_u32 s62, s61, 1204224
    s_min_u32 s45, s61, s62
    s_add_u32 m0, s57, 4096
    s_add_u32 s61, s45, 172032
    buffer_load_dwordx4 v206, s[28:31], s45 offen lds
    s_sub_u32 s62, s61, 1204224
    s_min_u32 s45, s61, s62
    s_waitcnt lgkmcnt(5)
    v_mfma_f32_32x32x16_bf16 v[184:199], v[128:131], v[96:99], v[184:199]
    v_mfma_f32_32x32x16_bf16 v[216:231], v[96:99], v[132:135], v[216:231]
    ds_read_b128 v[104:107], v13 offset:0
    ds_read_b64_tr_b16 v[144:145], v15 offset:8192
    ds_read_b64_tr_b16 v[146:147], v15 offset:8448
    ds_read_b64_tr_b16 v[148:149], v15 offset:24576
    ds_read_b64_tr_b16 v[150:151], v15 offset:24832
    s_waitcnt lgkmcnt(5)
    v_mfma_f32_32x32x16_bf16 v[184:199], v[136:139], v[100:103], v[184:199]
    v_mfma_f32_32x32x16_bf16 v[216:231], v[100:103], v[140:143], v[216:231]
    ds_read_b128 v[108:111], v14 offset:0
    ds_read_b64_tr_b16 v[152:153], v15 offset:12288
    ds_read_b64_tr_b16 v[154:155], v15 offset:12544
    ds_read_b64_tr_b16 v[156:157], v15 offset:28672
    ds_read_b64_tr_b16 v[158:159], v15 offset:28928
    s_waitcnt lgkmcnt(5)
    v_mfma_f32_32x32x16_bf16 v[184:199], v[144:147], v[104:107], v[184:199]
    v_mfma_f32_32x32x16_bf16 v[216:231], v[104:107], v[148:151], v[216:231]
    s_waitcnt lgkmcnt(0)
    v_mfma_f32_32x32x16_bf16 v[184:199], v[152:155], v[108:111], v[184:199]
    v_mfma_f32_32x32x16_bf16 v[216:231], v[108:111], v[156:159], v[216:231]
    v_add_u32 v11, 4294901760, v11
    v_add_u32 v12, 4294901760, v12
    v_add_u32 v13, 4294901760, v13
    v_add_u32 v14, 4294901760, v14
    v_add_u32 v15, 4294901760, v15
    s_waitcnt vmcnt(2) lgkmcnt(0)
    s_barrier
    v_cmp_ne_u32 vcc, v6, v7
    s_mov_b32 s46, vcc_lo
    ds_read_b128 v[112:115], v11 offset:0
    ds_read_b64_tr_b16 v[128:129], v15 offset:0
    ds_read_b64_tr_b16 v[130:131], v15 offset:256
    ds_read_b64_tr_b16 v[132:133], v15 offset:16384
    ds_read_b64_tr_b16 v[134:135], v15 offset:16640
    ds_read_b128 v[116:119], v12 offset:0
    ds_read_b64_tr_b16 v[136:137], v15 offset:4096
    ds_read_b64_tr_b16 v[138:139], v15 offset:4352
    ds_read_b64_tr_b16 v[140:141], v15 offset:20480
    ds_read_b64_tr_b16 v[142:143], v15 offset:20736
    s_add_u32 m0, s57, 8192
    s_add_u32 s61, s45, 172032
    buffer_load_dwordx4 v206, s[28:31], s45 offen lds
    s_sub_u32 s62, s61, 1204224
    s_min_u32 s45, s61, s62
    s_add_u32 m0, s57, 12288
    s_add_u32 s61, s45, 172032
    buffer_load_dwordx4 v206, s[28:31], s45 offen lds
    s_sub_u32 s62, s61, 1204224
    s_min_u32 s45, s61, s62
    s_waitcnt lgkmcnt(5)
    v_mfma_f32_32x32x16_bf16 v[184:199], v[128:131], v[112:115], v[184:199]
    v_mfma_f32_32x32x16_bf16 v[216:231], v[112:115], v[132:135], v[216:231]
    ds_read_b128 v[120:123], v13 offset:0
    ds_read_b64_tr_b16 v[144:145], v15 offset:8192
    ds_read_b64_tr_b16 v[146:147], v15 offset:8448
    ds_read_b64_tr_b16 v[148:149], v15 offset:24576
    ds_read_b64_tr_b16 v[150:151], v15 offset:24832
    s_waitcnt lgkmcnt(5)
    v_mfma_f32_32x32x16_bf16 v[184:199], v[136:139], v[116:119], v[184:199]
    v_mfma_f32_32x32x16_bf16 v[216:231], v[116:119], v[140:143], v[216:231]
    ds_read_b128 v[124:127], v14 offset:0
    ds_read_b64_tr_b16 v[152:153], v15 offset:12288
    ds_read_b64_tr_b16 v[154:155], v15 offset:12544
    ds_read_b64_tr_b16 v[156:157], v15 offset:28672
    ds_read_b64_tr_b16 v[158:159], v15 offset:28928
    s_waitcnt lgkmcnt(5)
    v_mfma_f32_32x32x16_bf16 v[184:199], v[144:147], v[120:123], v[184:199]
    v_mfma_f32_32x32x16_bf16 v[216:231], v[120:123], v[148:151], v[216:231]
    s_waitcnt lgkmcnt(0)
    v_mfma_f32_32x32x16_bf16 v[184:199], v[152:155], v[124:127], v[184:199]
    v_mfma_f32_32x32x16_bf16 v[216:231], v[124:127], v[156:159], v[216:231]
    s_cmp_eq_u32 s54, 1
    s_setprio 2
    s_cbranch_scc1 L_kv
    s_setprio 3
L_kv:
    s_nop 7
    v_cvt_pk_bf16_f32 v176, v184, v185
    v_cvt_pk_bf16_f32 v177, v186, v187
    v_cvt_pk_bf16_f32 v178, v188, v189
    v_cvt_pk_bf16_f32 v179, v190, v191
    v_cvt_pk_bf16_f32 v180, v192, v193
    v_cvt_pk_bf16_f32 v181, v194, v195
    v_cvt_pk_bf16_f32 v182, v196, v197
    v_cvt_pk_bf16_f32 v183, v198, v199
    s_mov_b64 exec, s[50:51]
    v_cvt_pk_bf16_f32 v208, v216, v217
    v_cvt_pk_bf16_f32 v209, v218, v219
    v_cvt_pk_bf16_f32 v210, v220, v221
    v_cvt_pk_bf16_f32 v211, v222, v223
    v_cvt_pk_bf16_f32 v212, v224, v225
    v_cvt_pk_bf16_f32 v213, v226, v227
    v_cvt_pk_bf16_f32 v214, v228, v229
    v_cvt_pk_bf16_f32 v215, v230, v231
    s_mov_b64 exec, -1
    s_cmp_lg_u32 s46, 0
    v_permlane32_swap_b32 v208, v210
    v_permlane32_swap_b32 v209, v211
    v_permlane32_swap_b32 v212, v214
    v_permlane32_swap_b32 v213, v215
    s_cbranch_scc1 L_farkv
    buffer_store_dwordx4 v[176:179], v3, s[32:35], s64 offen offset:0
    buffer_store_dwordx4 v[180:183], v3, s[32:35], s64 offen offset:1024
    buffer_store_dwordx4 v[208:211], v3, s[32:35], s64 offen offset:2048
    buffer_store_dwordx4 v[212:215], v3, s[32:35], s64 offen offset:3072
L_kvdone:
    s_add_u32 m0, s57, 16384
    s_add_u32 s61, s45, 172032
    buffer_load_dwordx4 v206, s[28:31], s45 offen lds
    s_sub_u32 s62, s61, 1204224
    s_min_u32 s45, s61, s62
    s_add_u32 m0, s57, 20480
    s_add_u32 s61, s45, 172032
    buffer_load_dwordx4 v206, s[28:31], s45 offen lds
    s_sub_u32 s62, s61, 1204224
    s_min_u32 s45, s61, s62
    s_add_u32 m0, s57, 24576
    s_add_u32 s61, s45, 172032
    buffer_load_dwordx4 v206, s[28:31], s45 offen lds
    s_sub_u32 s62, s61, 1204224
    s_min_u32 s45, s61, s62
    s_waitcnt vmcnt(7)
    ds_write_b64 v204, v[200:201]
    v_mov_b32 v251, 8
    ds_write_b32 v252, v251
    s_mov_b32 s69, 2097152
L_lw1:
    ds_read_b32 v250, v253
    s_sub_u32 s69, s69, 1
    s_waitcnt lgkmcnt(0)
    v_cmp_gt_u32 vcc, 8, v250
    s_cbranch_vccz L_lx1
    s_cbranch_scc0 L_lw1
L_lx1:
    ds_read_b64_tr_b16 v[128:129], v248 offset:0
    ds_read_b64_tr_b16 v[130:131], v248 offset:256
    ds_read_b64_tr_b16 v[132:133], v248 offset:1024
    ds_read_b64_tr_b16 v[134:135], v248 offset:1280
    ds_read_b64_tr_b16 v[136:137], v248 offset:2048
    ds_read_b64_tr_b16 v[138:139], v248 offset:2304
    ds_read_b64_tr_b16 v[140:141], v248 offset:3072
    ds_read_b64_tr_b16 v[142:143], v248 offset:3328
    ds_read_b64_tr_b16 v[144:145], v248 offset:4096
    ds_read_b64_tr_b16 v[146:147], v248 offset:4352
    ds_read_b64_tr_b16 v[148:149], v248 offset:5120
    ds_read_b64_tr_b16 v[150:151], v248 offset:5376
    ds_read_b64_tr_b16 v[152:153], v248 offset:6144
    ds_read_b64_tr_b16 v[154:155], v248 offset:6400
    s_waitcnt lgkmcnt(12)
    v_mfma_f32_32x32x16_bf16 v[232:247], v[128:131], v[16:19], 0
    ds_read_b64_tr_b16 v[156:157], v248 offset:7168
    ds_read_b64_tr_b16 v[158:159], v248 offset:7424
    s_waitcnt lgkmcnt(12)
    v_mfma_f32_32x32x16_bf16 v[232:247], v[132:135], v[20:23], v[232:247]
    ds_read_b64_tr_b16 v[128:129], v248 offset:8192
    ds_read_b64_tr_b16 v[130:131], v248 offset:8448
    s_waitcnt lgkmcnt(12)
    v_mfma_f32_32x32x16_bf16 v[232:247], v[136:139], v[24:27], v[232:247]
    v_mov_b32 v16, 0
    v_mov_b32 v17, 0
    v_mov_b32 v18, 0
    v_mov_b32 v19, 0
    ds_read_b64_tr_b16 v[132:133], v248 offset:9216
    ds_read_b64_tr_b16 v[134:135], v248 offset:9472
    s_waitcnt lgkmcnt(12)
    v_mfma_f32_32x32x16_bf16 v[232:247], v[140:143], v[28:31], v[232:247]
    v_mov_b32 v20, 0
    v_mov_b32 v21, 0
    v_mov_b32 v22, 0
    v_mov_b32 v23, 0
    ds_read_b64_tr_b16 v[136:137], v248 offset:10240
    ds_read_b64_tr_b16 v[138:139], v248 offset:10496
    s_waitcnt lgkmcnt(12)
    v_mfma_f32_32x32x16_bf16 v[232:247], v[144:147], v[32:35], v[232:247]
    v_mov_b32 v24, 0
    v_mov_b32 v25, 0
    v_mov_b32 v26, 0
    v_mov_b32 v27, 0
    s_lshl_b32 s61, s56, 2
    s_add_u32 s61, s61, s70
    s_waitcnt vmcnt(3)
    s_mov_b64 exec, 1
    s_cmp_lg_u32 s46, 0
    s_cbranch_scc1 L_farfl
    buffer_store_dword v5, off, s[36:39], s61
L_fldone:
    s_mov_b64 exec, -1
    ds_read_b64_tr_b16 v[140:141], v248 offset:11264
    ds_read_b64_tr_b16 v[142:143], v248 offset:11520
    s_waitcnt lgkmcnt(12)
    v_mfma_f32_32x32x16_bf16 v[232:247], v[148:151], v[36:39], v[232:247]
    v_mov_b32 v28, 0
    v_mov_b32 v29, 0
    v_mov_b32 v30, 0
    v_mov_b32 v31, 0
    ds_read_b64_tr_b16 v[144:145], v248 offset:12288
    ds_read_b64_tr_b16 v[146:147], v248 offset:12544
    s_waitcnt lgkmcnt(12)
    v_mfma_f32_32x32x16_bf16 v[232:247], v[152:155], v[40:43], v[232:247]
    v_mov_b32 v32, 0
    v_mov_b32 v33, 0
    v_mov_b32 v34, 0
    v_mov_b32 v35, 0
    ds_read_b64_tr_b16 v[148:149], v248 offset:13312
    ds_read_b64_tr_b16 v[150:151], v248 offset:13568
    s_waitcnt lgkmcnt(12)
    v_mfma_f32_32x32x16_bf16 v[232:247], v[156:159], v[44:47], v[232:247]
    v_mov_b32 v36, 0
    v_mov_b32 v37, 0
    v_mov_b32 v38, 0
    v_mov_b32 v39, 0
    ds_read_b64_tr_b16 v[152:153], v248 offset:14336
    ds_read_b64_tr_b16 v[154:155], v248 offset:14592
    s_waitcnt lgkmcnt(12)
    v_mfma_f32_32x32x16_bf16 v[232:247], v[128:131], v[48:51], v[232:247]
    v_mov_b32 v40, 0
    v_mov_b32 v41, 0
    v_mov_b32 v42, 0
    v_mov_b32 v43, 0
    ds_read_b64_tr_b16 v[156:157], v248 offset:15360
    ds_read_b64_tr_b16 v[158:159], v248 offset:15616
    s_waitcnt lgkmcnt(12)
    v_mfma_f32_32x32x16_bf16 v[232:247], v[132:135], v[52:55], v[232:247]
    v_mov_b32 v44, 0
    v_mov_b32 v45, 0
    v_mov_b32 v46, 0
    v_mov_b32 v47, 0
    s_waitcnt vmcnt(1)
    s_mov_b32 exec_hi, 0xffff
    ds_write_b64 v204, v[202:203] offset:16384
    s_mov_b32 exec_hi, -1
    v_mov_b32 v251, 9
    ds_write_b32 v252, v251
    s_mov_b32 s69, 2097152
L_lw2:
    ds_read_b32 v250, v253
    s_sub_u32 s69, s69, 1
    s_waitcnt lgkmcnt(0)
    v_cmp_gt_u32 vcc, 9, v250
    s_cbranch_vccz L_lx2
    s_cbranch_scc0 L_lw2
L_lx2:
    ds_read_b64_tr_b16 v[128:129], v248 offset:16384
    ds_read_b64_tr_b16 v[130:131], v248 offset:16640
    s_waitcnt lgkmcnt(12)
    v_mfma_f32_32x32x16_bf16 v[232:247], v[136:139], v[56:59], v[232:247]
    v_mov_b32 v48, 0
    v_mov_b32 v49, 0
    v_mov_b32 v50, 0
    v_mov_b32 v51, 0
    ds_read_b64_tr_b16 v[132:133], v248 offset:17408
    ds_read_b64_tr_b16 v[134:135], v248 offset:17664
    s_waitcnt lgkmcnt(12)
    v_mfma_f32_32x32x16_bf16 v[232:247], v[140:143], v[60:63], v[232:247]
    v_mov_b32 v52, 0
    v_mov_b32 v53, 0
    v_mov_b32 v54, 0
    v_mov_b32 v55, 0
    ds_read_b64_tr_b16 v[136:137], v248 offset:18432
    ds_read_b64_tr_b16 v[138:139], v248 offset:18688
    s_waitcnt lgkmcnt(12)
    v_mfma_f32_32x32x16_bf16 v[232:247], v[144:147], v[64:67], v[232:247]
    v_mov_b32 v56, 0
    v_mov_b32 v57, 0
    v_mov_b32 v58, 0
    v_mov_b32 v59, 0
    ds_read_b64_tr_b16 v[140:141], v248 offset:19456
    ds_read_b64_tr_b16 v[142:143], v248 offset:19712
    s_waitcnt lgkmcnt(12)
    v_mfma_f32_32x32x16_bf16 v[232:247], v[148:151], v[68:71], v[232:247]
    v_mov_b32 v60, 0
    v_mov_b32 v61, 0
    v_mov_b32 v62, 0
    v_mov_b32 v63, 0
    v_add_u32 v8, s56, v2
    s_mov_b32 s68, 0
    v_and_b32 v8, 15, v8
    v_lshlrev_b32 v8, 2, v8
    ds_read_b64_tr_b16 v[144:145], v248 offset:20480
    ds_read_b64_tr_b16 v[146:147], v248 offset:20736
    s_waitcnt lgkmcnt(12)
    v_mfma_f32_32x32x16_bf16 v[232:247], v[152:155], v[72:75], v[232:247]
    v_mov_b32 v64, 0
    v_mov_b32 v65, 0
    v_mov_b32 v66, 0
    v_mov_b32 v67, 0
    buffer_load_dword v7, v8, s[36:39], s70 offen sc1
    ds_read_b64_tr_b16 v[148:149], v248 offset:21504
    ds_read_b64_tr_b16 v[150:151], v248 offset:21760
    s_waitcnt lgkmcnt(12)
    v_mfma_f32_32x32x16_bf16 v[232:247], v[156:159], v[76:79], v[232:247]
    v_mov_b32 v68, 0
    v_mov_b32 v69, 0
    v_mov_b32 v70, 0
    v_mov_b32 v71, 0
    ds_read_b64_tr_b16 v[152:153], v248 offset:22528
    ds_read_b64_tr_b16 v[154:155], v248 offset:22784
    s_waitcnt lgkmcnt(12)
    v_mfma_f32_32x32x16_bf16 v[232:247], v[128:131], v[80:83], v[232:247]
    v_mov_b32 v72, 0
    v_mov_b32 v73, 0
    v_mov_b32 v74, 0
    v_mov_b32 v75, 0
    ds_read_b64_tr_b16 v[156:157], v248 offset:23552
    ds_read_b64_tr_b16 v[158:159], v248 offset:23808
    s_waitcnt lgkmcnt(12)
    v_mfma_f32_32x32x16_bf16 v[232:247], v[132:135], v[84:87], v[232:247]
    v_mov_b32 v76, 0
    v_mov_b32 v77, 0
    v_mov_b32 v78, 0
    v_mov_b32 v79, 0
    ds_read_b64_tr_b16 v[128:129], v248 offset:24576
    ds_read_b64_tr_b16 v[130:131], v248 offset:24832
    s_waitcnt lgkmcnt(12)
    v_mfma_f32_32x32x16_bf16 v[232:247], v[136:139], v[88:91], v[232:247]
    ds_read_b64_tr_b16 v[132:133], v248 offset:25600
    ds_read_b64_tr_b16 v[134:135], v248 offset:25856
    s_waitcnt lgkmcnt(12)
    v_mfma_f32_32x32x16_bf16 v[232:247], v[140:143], v[92:95], v[232:247]
    ds_read_b64_tr_b16 v[136:137], v248 offset:26624
    ds_read_b64_tr_b16 v[138:139], v248 offset:26880
    s_waitcnt lgkmcnt(12)
    v_mfma_f32_32x32x16_bf16 v[232:247], v[144:147], v[96:99], v[232:247]
    ds_read_b64_tr_b16 v[140:141], v248 offset:27648
    ds_read_b64_tr_b16 v[142:143], v248 offset:27904
    s_waitcnt lgkmcnt(12)
    v_mfma_f32_32x32x16_bf16 v[232:247], v[148:151], v[100:103], v[232:247]
    s_waitcnt lgkmcnt(10)
    v_mfma_f32_32x32x16_bf16 v[232:247], v[152:155], v[104:107], v[232:247]
    s_waitcnt vmcnt(0)
    v_cmp_ne_u32 vcc, v5, v7
    s_and_b32 s61, vcc_lo, 0xe
    s_cbranch_scc1 L_ek0
    s_add_u32 s64, s64, 16384
    s_and_b32 s64, s64, 0x3ffff
    buffer_load_dwordx4 v[184:187], v3, s[32:35], s64 offen sc1
    buffer_load_dwordx4 v[188:191], v3, s[32:35], s64 offen offset:1024 sc1
    buffer_load_dwordx4 v[216:219], v3, s[32:35], s64 offen offset:2048 sc1
    buffer_load_dwordx4 v[220:223], v3, s[32:35], s64 offen offset:3072 sc1
    s_mov_b32 s68, 2
L_ek0:
    s_waitcnt lgkmcnt(8)
    v_mfma_f32_32x32x16_bf16 v[232:247], v[156:159], v[108:111], v[232:247]
    s_waitcnt lgkmcnt(6)
    v_mfma_f32_32x32x16_bf16 v[232:247], v[128:131], v[112:115], v[232:247]
    s_waitcnt lgkmcnt(4)
    v_mfma_f32_32x32x16_bf16 v[232:247], v[132:135], v[116:119], v[232:247]
    s_waitcnt lgkmcnt(2)
    v_mfma_f32_32x32x16_bf16 v[232:247], v[136:139], v[120:123], v[232:247]
    s_waitcnt lgkmcnt(0)
    v_mfma_f32_32x32x16_bf16 v[232:247], v[140:143], v[124:127], v[232:247]
    s_mov_b32 s62, 0x3e8b97f6
    s_lshl_b32 s61, s53, 11
    s_add_u32 s61, s61, s48
    v_add_u32 v1, s61, v3
    v_cmp_gt_u32 vcc, 32, v2
    s_nop 6
    v_mov_b32 v205, v244
    v_mov_b32 v6, v244
    v_mul_f32 v232, s62, v232
    v_mul_f32 v233, s62, v233
    v_mul_f32 v234, s62, v234
    v_mul_f32 v235, s62, v235
    v_mul_f32 v236, s62, v236
    v_mul_f32 v237, s62, v237
    v_mul_f32 v238, s62, v238
    v_mul_f32 v239, s62, v239
    v_mul_f32 v240, s62, v240
    v_mul_f32 v241, s62, v241
    v_mul_f32 v242, s62, v242
    v_mul_f32 v243, s62, v243
    v_mul_f32 v244, s62, v244
    v_mul_f32 v245, s62, v245
    v_mul_f32 v246, s62, v246
    v_mul_f32 v247, s62, v247
    v_cvt_pk_bf16_f32 v232, v232, v233
    v_cvt_pk_bf16_f32 v233, v234, v235
    v_cvt_pk_bf16_f32 v234, v236, v237
    v_cvt_pk_bf16_f32 v235, v238, v239
    v_cvt_pk_bf16_f32 v236, v240, v241
    v_cvt_pk_bf16_f32 v237, v242, v243
    v_cvt_pk_bf16_f32 v238, v244, v245
    v_cvt_pk_bf16_f32 v239, v246, v247
    v_cndmask_b32 v238, 0, v238, vcc
    v_cndmask_b32 v239, 0, v239, vcc
    ds_write_b128 v1, v[232:235]
    ds_write_b128 v1, v[236:239] offset:1024
    v_mov_b32 v251, 12
    ds_write_b32 v252, v251
    s_add_u32 s61, s53, 1
    s_and_b32 s61, s61, 3
    s_lshl_b32 s62, s61, 11
    s_mul_i32 s61, s61, 12288
    s_add_u32 s62, s62, s48
    s_add_u32 s61, s61, 98304
    v_add_u32 v240, s62, v3
    v_add_u32 v12, s61, v3
    s_add_u32 s61, s53, 2
    s_and_b32 s61, s61, 3
    s_lshl_b32 s62, s61, 11
    s_mul_i32 s61, s61, 12288
    s_add_u32 s62, s62, s48
    s_add_u32 s61, s61, 102400
    v_add_u32 v241, s62, v3
    v_add_u32 v13, s61, v3
    s_add_u32 s61, s53, 3
    s_and_b32 s61, s61, 3
    s_lshl_b32 s62, s61, 11
    s_mul_i32 s61, s61, 12288
    s_add_u32 s62, s62, s48
    s_add_u32 s61, s61, 106496
    v_add_u32 v242, s62, v3
    v_add_u32 v14, s61, v3
    s_add_u32 s61, s53, 4
    s_and_b32 s61, s61, 3
    s_lshl_b32 s62, s61, 11
    s_mul_i32 s61, s61, 12288
    s_add_u32 s62, s62, s48
    s_add_u32 s61, s61, 98304
    v_add_u32 v243, s62, v3
    v_add_u32 v11, s61, v3
    s_cmp_lt_u32 s55, 8
    s_mov_b32 s62, 0x3fb8aa3b
    s_cselect_b32 s63, 0xbfb8aa3b, s62
    v_permlane32_swap_b32 v205, v6
    s_nop 0
    v_mul_f32 v6, s63, v6
    v_exp_f32 v6, v6
    s_nop 0
    v_add_f32 v6, 1.0, v6
    v_rcp_f32 v6, v6
L_att:
    buffer_load_dword v7, v8, s[36:39], s70 offen sc1
    s_mov_b32 s69, 2097152
L_lw3:
    ds_read_b32 v250, v253
    s_sub_u32 s69, s69, 1
    s_waitcnt lgkmcnt(0)
    v_cmp_gt_u32 vcc, 12, v250
    s_cbranch_vccz L_lx3
    s_cbranch_scc0 L_lw3
L_lx3:
    ds_read_b128 v[144:147], v240
    ds_read_b128 v[148:151], v240 offset:1024
    ds_read_b128 v[152:155], v241
    ds_read_b128 v[156:159], v241 offset:1024
    ds_read_b128 v[160:163], v242
    ds_read_b128 v[164:167], v242 offset:1024
    ds_read_b128 v[168:171], v243
    ds_read_b128 v[172:175], v243 offset:1024
    v_mov_b32 v251, 13
    ds_write_b32 v252, v251
    s_mov_b32 s66, 3
    s_mov_b32 s67, 0
    s_mov_b32 s69, 65536
    s_cmp_eq_u32 s68, 0
    s_cbranch_scc1 L_e3
    s_add_u32 s64, s64, 16384
    s_and_b32 s64, s64, 0x3ffff
    buffer_load_dwordx4 v[192:195], v3, s[32:35], s64 offen sc1
    buffer_load_dwordx4 v[196:199], v3, s[32:35], s64 offen offset:1024 sc1
    buffer_load_dwordx4 v[224:227], v3, s[32:35], s64 offen offset:2048 sc1
    buffer_load_dwordx4 v[228:231], v3, s[32:35], s64 offen offset:3072 sc1
    s_add_u32 s64, s64, 16384
    s_and_b32 s64, s64, 0x3ffff
    buffer_load_dwordx4 v[200:203], v3, s[32:35], s64 offen sc1
    buffer_load_dwordx4 v[204:207], v3, s[32:35], s64 offen offset:1024 sc1
    buffer_load_dwordx4 v[232:235], v3, s[32:35], s64 offen offset:2048 sc1
    buffer_load_dwordx4 v[236:239], v3, s[32:35], s64 offen offset:3072 sc1
L_e3:
    s_cmp_lg_u32 s68, 0
    s_cbranch_scc1 L_ska
L_spa:
    s_waitcnt vmcnt(0)
    v_cmp_ne_u32 vcc, v5, v7
    s_and_b32 s61, vcc_lo, 0xe
    s_cbranch_scc0 L_lda
    buffer_load_dword v7, v8, s[36:39], s70 offen sc1
    s_branch L_ska
L_lda:
    s_add_u32 s64, s64, 16384
    s_and_b32 s64, s64, 0x3ffff
    buffer_load_dwordx4 v[184:187], v3, s[32:35], s64 offen sc1
    buffer_load_dwordx4 v[188:191], v3, s[32:35], s64 offen offset:1024 sc1
    buffer_load_dwordx4 v[216:219], v3, s[32:35], s64 offen offset:2048 sc1
    buffer_load_dwordx4 v[220:223], v3, s[32:35], s64 offen offset:3072 sc1
    s_add_u32 s64, s64, 16384
    s_and_b32 s64, s64, 0x3ffff
    buffer_load_dwordx4 v[192:195], v3, s[32:35], s64 offen sc1
    buffer_load_dwordx4 v[196:199], v3, s[32:35], s64 offen offset:1024 sc1
    buffer_load_dwordx4 v[224:227], v3, s[32:35], s64 offen offset:2048 sc1
    buffer_load_dwordx4 v[228:231], v3, s[32:35], s64 offen offset:3072 sc1
    s_add_u32 s64, s64, 16384
    s_and_b32 s64, s64, 0x3ffff
    buffer_load_dwordx4 v[200:203], v3, s[32:35], s64 offen sc1
    buffer_load_dwordx4 v[204:207], v3, s[32:35], s64 offen offset:1024 sc1
    buffer_load_dwordx4 v[232:235], v3, s[32:35], s64 offen offset:2048 sc1
    buffer_load_dwordx4 v[236:239], v3, s[32:35], s64 offen offset:3072 sc1
    v_mov_b32 v251, 14
    ds_write_b32 v252, v251
    s_mov_b32 s68, 1
L_ska:
    s_waitcnt lgkmcnt(7)
    v_mfma_f32_32x32x16_bf16 v[80:95], v[176:179], v[144:147], 0
    v_mfma_f32_32x32x16_bf16 v[80:95], v[180:183], v[148:151], v[80:95]
    s_waitcnt lgkmcnt(0)
    s_nop 9
    v_mfma_f32_32x32x16_bf16 v[96:111], v[176:179], v[152:155], 0
    v_exp_f32 v80, v80
    v_exp_f32 v81, v81
    v_exp_f32 v82, v82
    v_exp_f32 v83, v83
    v_mfma_f32_32x32x16_bf16 v[96:111], v[180:183], v[156:159], v[96:111]
    v_exp_f32 v84, v84
    v_exp_f32 v85, v85
    v_exp_f32 v86, v86
    v_exp_f32 v87, v87
    v_exp_f32 v88, v88
    v_exp_f32 v89, v89
    v_exp_f32 v90, v90
    v_exp_f32 v91, v91
    v_exp_f32 v92, v92
    v_exp_f32 v93, v93
    v_exp_f32 v94, v94
    v_exp_f32 v95, v95
    v_mfma_f32_32x32x16_bf16 v[112:127], v[176:179], v[160:163], 0
    v_exp_f32 v96, v96
    v_exp_f32 v97, v97
    v_exp_f32 v98, v98
    v_exp_f32 v99, v99
    v_mfma_f32_32x32x16_bf16 v[112:127], v[180:183], v[164:167], v[112:127]
    v_exp_f32 v100, v100
    v_exp_f32 v101, v101
    v_exp_f32 v102, v102
    v_exp_f32 v103, v103
    v_smfmac_f32_32x32x32_bf16 v[16:31], v[208:211], v[80:87], v4
    v_exp_f32 v104, v104
    v_exp_f32 v105, v105
    v_exp_f32 v106, v106
    v_exp_f32 v107, v107
    v_smfmac_f32_32x32x32_bf16 v[16:31], v[212:215], v[88:95], v4
    v_exp_f32 v108, v108
    v_exp_f32 v109, v109
    v_exp_f32 v110, v110
    v_exp_f32 v111, v111
    s_cmp_lg_u32 s68, 0
    s_cbranch_scc1 L_sk1
L_sp1:
    s_waitcnt vmcnt(0)
    v_cmp_ne_u32 vcc, v5, v7
    s_and_b32 s61, vcc_lo, 0xe
    s_cbranch_scc0 L_ld1
    buffer_load_dword v7, v8, s[36:39], s70 offen sc1
    s_branch L_sk1
L_ld1:
    s_add_u32 s64, s64, 16384
    s_and_b32 s64, s64, 0x3ffff
    buffer_load_dwordx4 v[184:187], v3, s[32:35], s64 offen sc1
    buffer_load_dwordx4 v[188:191], v3, s[32:35], s64 offen offset:1024 sc1
    buffer_load_dwordx4 v[216:219], v3, s[32:35], s64 offen offset:2048 sc1
    buffer_load_dwordx4 v[220:223], v3, s[32:35], s64 offen offset:3072 sc1
    s_add_u32 s64, s64, 16384
    s_and_b32 s64, s64, 0x3ffff
    buffer_load_dwordx4 v[192:195], v3, s[32:35], s64 offen sc1
    buffer_load_dwordx4 v[196:199], v3, s[32:35], s64 offen offset:1024 sc1
    buffer_load_dwordx4 v[224:227], v3, s[32:35], s64 offen offset:2048 sc1
    buffer_load_dwordx4 v[228:231], v3, s[32:35], s64 offen offset:3072 sc1
    s_add_u32 s64, s64, 16384
    s_and_b32 s64, s64, 0x3ffff
    buffer_load_dwordx4 v[200:203], v3, s[32:35], s64 offen sc1
    buffer_load_dwordx4 v[204:207], v3, s[32:35], s64 offen offset:1024 sc1
    buffer_load_dwordx4 v[232:235], v3, s[32:35], s64 offen offset:2048 sc1
    buffer_load_dwordx4 v[236:239], v3, s[32:35], s64 offen offset:3072 sc1
    v_mov_b32 v251, 14
    ds_write_b32 v252, v251
    s_mov_b32 s68, 1
L_sk1:
    v_mfma_f32_32x32x16_bf16 v[128:143], v[176:179], v[168:171], 0
    v_exp_f32 v112, v112
    v_exp_f32 v113, v113
    v_exp_f32 v114, v114
    v_exp_f32 v115, v115
    v_mfma_f32_32x32x16_bf16 v[128:143], v[180:183], v[172:175], v[128:143]
    v_exp_f32 v116, v116
    v_exp_f32 v117, v117
    v_exp_f32 v118, v118
    v_exp_f32 v119, v119
    v_smfmac_f32_32x32x32_bf16 v[32:47], v[208:211], v[96:103], v4
    v_exp_f32 v120, v120
    v_exp_f32 v121, v121
    v_exp_f32 v122, v122
    v_exp_f32 v123, v123
    v_smfmac_f32_32x32x32_bf16 v[32:47], v[212:215], v[104:111], v4
    v_exp_f32 v124, v124
    v_exp_f32 v125, v125
    v_exp_f32 v126, v126
    v_exp_f32 v127, v127
    s_cmp_lg_u32 s68, 0
    s_cbranch_scc1 L_sk2
L_sp2:
    s_waitcnt vmcnt(0)
    v_cmp_ne_u32 vcc, v5, v7
    s_and_b32 s61, vcc_lo, 0xe
    s_cbranch_scc0 L_ld2
    buffer_load_dword v7, v8, s[36:39], s70 offen sc1
    s_sub_u32 s69, s69, 1
    s_cbranch_scc0 L_sp2
L_ld2:
    s_add_u32 s64, s64, 16384
    s_and_b32 s64, s64, 0x3ffff
    buffer_load_dwordx4 v[184:187], v3, s[32:35], s64 offen sc1
    buffer_load_dwordx4 v[188:191], v3, s[32:35], s64 offen offset:1024 sc1
    buffer_load_dwordx4 v[216:219], v3, s[32:35], s64 offen offset:2048 sc1
    buffer_load_dwordx4 v[220:223], v3, s[32:35], s64 offen offset:3072 sc1
    s_add_u32 s64, s64, 16384
    s_and_b32 s64, s64, 0x3ffff
    buffer_load_dwordx4 v[192:195], v3, s[32:35], s64 offen sc1
    buffer_load_dwordx4 v[196:199], v3, s[32:35], s64 offen offset:1024 sc1
    buffer_load_dwordx4 v[224:227], v3, s[32:35], s64 offen offset:2048 sc1
    buffer_load_dwordx4 v[228:231], v3, s[32:35], s64 offen offset:3072 sc1
    s_add_u32 s64, s64, 16384
    s_and_b32 s64, s64, 0x3ffff
    buffer_load_dwordx4 v[200:203], v3, s[32:35], s64 offen sc1
    buffer_load_dwordx4 v[204:207], v3, s[32:35], s64 offen offset:1024 sc1
    buffer_load_dwordx4 v[232:235], v3, s[32:35], s64 offen offset:2048 sc1
    buffer_load_dwordx4 v[236:239], v3, s[32:35], s64 offen offset:3072 sc1
    v_mov_b32 v251, 14
    ds_write_b32 v252, v251
    s_mov_b32 s68, 1
L_sk2:
    s_cmp_eq_u32 s68, 2
    s_cbranch_scc0 L_nref
    s_waitcnt vmcnt(8)
    v_cmp_ne_u32 vcc, v5, v7
L_nref:
    buffer_load_dword v7, v8, s[36:39], s70 offen sc1
    v_exp_f32 v128, v128
    v_exp_f32 v129, v129
    v_exp_f32 v130, v130
    v_exp_f32 v131, v131
    v_exp_f32 v132, v132
    v_exp_f32 v133, v133
    v_exp_f32 v134, v134
    v_exp_f32 v135, v135
    v_smfmac_f32_32x32x32_bf16 v[48:63], v[208:211], v[112:119], v4
    v_exp_f32 v136, v136
    v_exp_f32 v137, v137
    v_exp_f32 v138, v138
    v_exp_f32 v139, v139
    v_smfmac_f32_32x32x32_bf16 v[48:63], v[212:215], v[120:127], v4
    v_exp_f32 v140, v140
    v_exp_f32 v141, v141
    v_exp_f32 v142, v142
    v_exp_f32 v143, v143
    s_and_b32 s61, vcc_lo, 0xfffe
    s_cbranch_scc0 L_go2
    s_mov_b32 s69, 65536
L_spin2:
    s_waitcnt vmcnt(0)
    v_cmp_ne_u32 vcc, v5, v7
    s_and_b32 s61, vcc_lo, 0xfffe
    s_cbranch_scc0 L_go2
    buffer_load_dword v7, v8, s[36:39], s70 offen sc1
    s_sub_u32 s69, s69, 1
    s_cbranch_scc0 L_spin2
L_go2:
    s_waitcnt vmcnt(9)
    v_mfma_f32_32x32x16_bf16 v[80:95], v[184:187], v[144:147], 0
    v_mfma_f32_32x32x16_bf16 v[80:95], v[188:191], v[148:151], v[80:95]
    s_add_u32 s64, s64, 16384
    s_and_b32 s64, s64, 0x3ffff
    buffer_load_dwordx4 v[176:179], v3, s[32:35], s64 offen sc1
    buffer_load_dwordx4 v[180:183], v3, s[32:35], s64 offen offset:1024 sc1
    s_andn2_b32 s61, s2, 7
    s_add_u32 s61, s61, s52
    s_cmp_eq_u32 s61, 224
    s_cselect_b32 s68, 2, -1
    s_cmp_eq_u32 s54, 0
    s_setprio 1
    s_cbranch_scc1 L_pr
    s_setprio 0
L_pr:
    s_nop 3
.p2align 6
L_loop:
    v_mfma_f32_32x32x16_bf16 v[96:111], v[184:187], v[152:155], 0
    v_exp_f32 v80, v80
    v_exp_f32 v81, v81
    v_exp_f32 v82, v82
    v_exp_f32 v83, v83
    v_mfma_f32_32x32x16_bf16 v[96:111], v[188:191], v[156:159], v[96:111]
    v_exp_f32 v84, v84
    v_exp_f32 v85, v85
    v_exp_f32 v86, v86
    v_exp_f32 v87, v87
    v_smfmac_f32_32x32x32_bf16 v[64:79], v[208:211], v[128:135], v4
    v_exp_f32 v88, v88
    v_exp_f32 v89, v89
    v_exp_f32 v90, v90
    v_exp_f32 v91, v91
    v_smfmac_f32_32x32x32_bf16 v[64:79], v[212:215], v[136:143], v4
    v_exp_f32 v92, v92
    v_exp_f32 v93, v93
    v_exp_f32 v94, v94
    v_exp_f32 v95, v95
    v_mfma_f32_32x32x16_bf16 v[112:127], v[184:187], v[160:163], 0
    v_exp_f32 v96, v96
    v_exp_f32 v97, v97
    v_exp_f32 v98, v98
    v_exp_f32 v99, v99
    v_mfma_f32_32x32x16_bf16 v[112:127], v[188:191], v[164:167], v[112:127]
    v_exp_f32 v100, v100
    v_exp_f32 v101, v101
    v_exp_f32 v102, v102
    v_exp_f32 v103, v103
    v_smfmac_f32_32x32x32_bf16 v[16:31], v[216:219], v[80:87], v4
    buffer_load_dwordx4 v[208:211], v3, s[32:35], s64 offen offset:2048 sc1
    buffer_load_dwordx4 v[212:215], v3, s[32:35], s64 offen offset:3072 sc1
    v_exp_f32 v104, v104
    v_exp_f32 v105, v105
    v_exp_f32 v106, v106
    v_exp_f32 v107, v107
    v_smfmac_f32_32x32x32_bf16 v[16:31], v[220:223], v[88:95], v4
    v_exp_f32 v108, v108
    v_exp_f32 v109, v109
    v_exp_f32 v110, v110
    v_exp_f32 v111, v111
    v_mfma_f32_32x32x16_bf16 v[128:143], v[184:187], v[168:171], 0
    v_exp_f32 v112, v112
    v_exp_f32 v113, v113
    v_exp_f32 v114, v114
    v_exp_f32 v115, v115
    v_mfma_f32_32x32x16_bf16 v[128:143], v[188:191], v[172:175], v[128:143]
    v_exp_f32 v116, v116
    v_exp_f32 v117, v117
    v_exp_f32 v118, v118
    v_exp_f32 v119, v119
    v_smfmac_f32_32x32x32_bf16 v[32:47], v[216:219], v[96:103], v4
    v_exp_f32 v120, v120
    v_exp_f32 v121, v121
    v_exp_f32 v122, v122
    v_exp_f32 v123, v123
    v_smfmac_f32_32x32x32_bf16 v[32:47], v[220:223], v[104:111], v4
    v_exp_f32 v124, v124
    v_exp_f32 v125, v125
    v_exp_f32 v126, v126
    v_exp_f32 v127, v127
    s_waitcnt vmcnt(8)
    v_mfma_f32_32x32x16_bf16 v[80:95], v[192:195], v[144:147], 0
    v_exp_f32 v128, v128
    v_exp_f32 v129, v129
    v_exp_f32 v130, v130
    v_exp_f32 v131, v131
    v_mfma_f32_32x32x16_bf16 v[80:95], v[196:199], v[148:151], v[80:95]
    v_exp_f32 v132, v132
    v_exp_f32 v133, v133
    v_exp_f32 v134, v134
    v_exp_f32 v135, v135
    v_smfmac_f32_32x32x32_bf16 v[48:63], v[216:219], v[112:119], v4
    s_add_u32 s64, s64, 16384
    s_and_b32 s64, s64, 0x3ffff
    buffer_load_dwordx4 v[184:187], v3, s[32:35], s64 offen sc1
    buffer_load_dwordx4 v[188:191], v3, s[32:35], s64 offen offset:1024 sc1
    v_exp_f32 v136, v136
    v_exp_f32 v137, v137
    v_exp_f32 v138, v138
    v_exp_f32 v139, v139
    v_smfmac_f32_32x32x32_bf16 v[48:63], v[220:223], v[120:127], v4
    v_exp_f32 v140, v140
    v_exp_f32 v141, v141
    v_exp_f32 v142, v142
    v_exp_f32 v143, v143
    v_mfma_f32_32x32x16_bf16 v[96:111], v[192:195], v[152:155], 0
    v_exp_f32 v80, v80
    v_exp_f32 v81, v81
    v_exp_f32 v82, v82
    v_exp_f32 v83, v83
    v_mfma_f32_32x32x16_bf16 v[96:111], v[196:199], v[156:159], v[96:111]
    v_exp_f32 v84, v84
    v_exp_f32 v85, v85
    v_exp_f32 v86, v86
    v_exp_f32 v87, v87
    v_smfmac_f32_32x32x32_bf16 v[64:79], v[216:219], v[128:135], v4
    v_exp_f32 v88, v88
    v_exp_f32 v89, v89
    v_exp_f32 v90, v90
    v_exp_f32 v91, v91
    v_smfmac_f32_32x32x32_bf16 v[64:79], v[220:223], v[136:143], v4
    v_exp_f32 v92, v92
    v_exp_f32 v93, v93
    v_exp_f32 v94, v94
    v_exp_f32 v95, v95
    v_mfma_f32_32x32x16_bf16 v[112:127], v[192:195], v[160:163], 0
    v_exp_f32 v96, v96
    v_exp_f32 v97, v97
    v_exp_f32 v98, v98
    v_exp_f32 v99, v99
    v_mfma_f32_32x32x16_bf16 v[112:127], v[196:199], v[164:167], v[112:127]
    v_exp_f32 v100, v100
    v_exp_f32 v101, v101
    v_exp_f32 v102, v102
    v_exp_f32 v103, v103
    v_smfmac_f32_32x32x32_bf16 v[16:31], v[224:227], v[80:87], v4
    buffer_load_dwordx4 v[216:219], v3, s[32:35], s64 offen offset:2048 sc1
    buffer_load_dwordx4 v[220:223], v3, s[32:35], s64 offen offset:3072 sc1
    v_exp_f32 v104, v104
    v_exp_f32 v105, v105
    v_exp_f32 v106, v106
    v_exp_f32 v107, v107
    v_smfmac_f32_32x32x32_bf16 v[16:31], v[228:231], v[88:95], v4
    v_exp_f32 v108, v108
    v_exp_f32 v109, v109
    v_exp_f32 v110, v110
    v_exp_f32 v111, v111
    v_mfma_f32_32x32x16_bf16 v[128:143], v[192:195], v[168:171], 0
    v_exp_f32 v112, v112
    v_exp_f32 v113, v113
    v_exp_f32 v114, v114
    v_exp_f32 v115, v115
    v_mfma_f32_32x32x16_bf16 v[128:143], v[196:199], v[172:175], v[128:143]
    v_exp_f32 v116, v116
    v_exp_f32 v117, v117
    v_exp_f32 v118, v118
    v_exp_f32 v119, v119
    v_smfmac_f32_32x32x32_bf16 v[32:47], v[224:227], v[96:103], v4
    v_exp_f32 v120, v120
    v_exp_f32 v121, v121
    v_exp_f32 v122, v122
    v_exp_f32 v123, v123
    v_smfmac_f32_32x32x32_bf16 v[32:47], v[228:231], v[104:111], v4
    v_exp_f32 v124, v124
    v_exp_f32 v125, v125
    v_exp_f32 v126, v126
    v_exp_f32 v127, v127
    s_waitcnt vmcnt(8)
    v_mfma_f32_32x32x16_bf16 v[80:95], v[200:203], v[144:147], 0
    v_exp_f32 v128, v128
    v_exp_f32 v129, v129
    v_exp_f32 v130, v130
    v_exp_f32 v131, v131
    v_mfma_f32_32x32x16_bf16 v[80:95], v[204:207], v[148:151], v[80:95]
    v_exp_f32 v132, v132
    v_exp_f32 v133, v133
    v_exp_f32 v134, v134
    v_exp_f32 v135, v135
    v_smfmac_f32_32x32x32_bf16 v[48:63], v[224:227], v[112:119], v4
    s_add_u32 s64, s64, 16384
    s_and_b32 s64, s64, 0x3ffff
    buffer_load_dwordx4 v[192:195], v3, s[32:35], s64 offen sc1
    buffer_load_dwordx4 v[196:199], v3, s[32:35], s64 offen offset:1024 sc1
    v_exp_f32 v136, v136
    v_exp_f32 v137, v137
    v_exp_f32 v138, v138
    v_exp_f32 v139, v139
    v_smfmac_f32_32x32x32_bf16 v[48:63], v[228:231], v[120:127], v4
    v_exp_f32 v140, v140
    v_exp_f32 v141, v141
    v_exp_f32 v142, v142
    v_exp_f32 v143, v143
    s_sub_u32 s66, s66, 1
    s_cbranch_scc1 L_last
    v_mfma_f32_32x32x16_bf16 v[96:111], v[200:203], v[152:155], 0
    v_exp_f32 v80, v80
    v_exp_f32 v81, v81
    v_exp_f32 v82, v82
    v_exp_f32 v83, v83
    v_mfma_f32_32x32x16_bf16 v[96:111], v[204:207], v[156:159], v[96:111]
    v_exp_f32 v84, v84
    v_exp_f32 v85, v85
    v_exp_f32 v86, v86
    v_exp_f32 v87, v87
    v_smfmac_f32_32x32x32_bf16 v[64:79], v[224:227], v[128:135], v4
    v_exp_f32 v88, v88
    v_exp_f32 v89, v89
    v_exp_f32 v90, v90
    v_exp_f32 v91, v91
    v_smfmac_f32_32x32x32_bf16 v[64:79], v[228:231], v[136:143], v4
    v_exp_f32 v92, v92
    v_exp_f32 v93, v93
    v_exp_f32 v94, v94
    v_exp_f32 v95, v95
    v_mfma_f32_32x32x16_bf16 v[112:127], v[200:203], v[160:163], 0
    v_exp_f32 v96, v96
    v_exp_f32 v97, v97
    v_exp_f32 v98, v98
    v_exp_f32 v99, v99
    v_mfma_f32_32x32x16_bf16 v[112:127], v[204:207], v[164:167], v[112:127]
    v_exp_f32 v100, v100
    v_exp_f32 v101, v101
    v_exp_f32 v102, v102
    v_exp_f32 v103, v103
    v_smfmac_f32_32x32x32_bf16 v[16:31], v[232:235], v[80:87], v4
    buffer_load_dwordx4 v[224:227], v3, s[32:35], s64 offen offset:2048 sc1
    buffer_load_dwordx4 v[228:231], v3, s[32:35], s64 offen offset:3072 sc1
    v_exp_f32 v104, v104
    v_exp_f32 v105, v105
    v_exp_f32 v106, v106
    v_exp_f32 v107, v107
    v_smfmac_f32_32x32x32_bf16 v[16:31], v[236:239], v[88:95], v4
    v_exp_f32 v108, v108
    v_exp_f32 v109, v109
    v_exp_f32 v110, v110
    v_exp_f32 v111, v111
    v_mfma_f32_32x32x16_bf16 v[128:143], v[200:203], v[168:171], 0
    v_exp_f32 v112, v112
    v_exp_f32 v113, v113
    v_exp_f32 v114, v114
    v_exp_f32 v115, v115
    v_mfma_f32_32x32x16_bf16 v[128:143], v[204:207], v[172:175], v[128:143]
    v_exp_f32 v116, v116
    v_exp_f32 v117, v117
    v_exp_f32 v118, v118
    v_exp_f32 v119, v119
    v_smfmac_f32_32x32x32_bf16 v[32:47], v[232:235], v[96:103], v4
    v_exp_f32 v120, v120
    v_exp_f32 v121, v121
    v_exp_f32 v122, v122
    v_exp_f32 v123, v123
    v_smfmac_f32_32x32x32_bf16 v[32:47], v[236:239], v[104:111], v4
    v_exp_f32 v124, v124
    v_exp_f32 v125, v125
    v_exp_f32 v126, v126
    v_exp_f32 v127, v127
    s_waitcnt vmcnt(8)
    v_mfma_f32_32x32x16_bf16 v[80:95], v[176:179], v[144:147], 0
    v_exp_f32 v128, v128
    v_exp_f32 v129, v129
    v_exp_f32 v130, v130
    v_exp_f32 v131, v131
    v_mfma_f32_32x32x16_bf16 v[80:95], v[180:183], v[148:151], v[80:95]
    v_exp_f32 v132, v132
    v_exp_f32 v133, v133
    v_exp_f32 v134, v134
    v_exp_f32 v135, v135
    v_smfmac_f32_32x32x32_bf16 v[48:63], v[232:235], v[112:119], v4
    s_add_u32 s64, s64, 16384
    s_and_b32 s64, s64, 0x3ffff
    buffer_load_dwordx4 v[200:203], v3, s[32:35], s64 offen sc1
    buffer_load_dwordx4 v[204:207], v3, s[32:35], s64 offen offset:1024 sc1
    v_exp_f32 v136, v136
    v_exp_f32 v137, v137
    v_exp_f32 v138, v138
    v_exp_f32 v139, v139
    v_smfmac_f32_32x32x32_bf16 v[48:63], v[236:239], v[120:127], v4
    v_exp_f32 v140, v140
    v_exp_f32 v141, v141
    v_exp_f32 v142, v142
    v_exp_f32 v143, v143
    v_mfma_f32_32x32x16_bf16 v[96:111], v[176:179], v[152:155], 0
    v_exp_f32 v80, v80
    v_exp_f32 v81, v81
    v_exp_f32 v82, v82
    v_exp_f32 v83, v83
    v_mfma_f32_32x32x16_bf16 v[96:111], v[180:183], v[156:159], v[96:111]
    v_exp_f32 v84, v84
    v_exp_f32 v85, v85
    v_exp_f32 v86, v86
    v_exp_f32 v87, v87
    v_smfmac_f32_32x32x32_bf16 v[64:79], v[232:235], v[128:135], v4
    v_exp_f32 v88, v88
    v_exp_f32 v89, v89
    v_exp_f32 v90, v90
    v_exp_f32 v91, v91
    v_smfmac_f32_32x32x32_bf16 v[64:79], v[236:239], v[136:143], v4
    v_exp_f32 v92, v92
    v_exp_f32 v93, v93
    v_exp_f32 v94, v94
    v_exp_f32 v95, v95
    v_mfma_f32_32x32x16_bf16 v[112:127], v[176:179], v[160:163], 0
    v_exp_f32 v96, v96
    v_exp_f32 v97, v97
    v_exp_f32 v98, v98
    v_exp_f32 v99, v99
    v_mfma_f32_32x32x16_bf16 v[112:127], v[180:183], v[164:167], v[112:127]
    v_exp_f32 v100, v100
    v_exp_f32 v101, v101
    v_exp_f32 v102, v102
    v_exp_f32 v103, v103
    v_smfmac_f32_32x32x32_bf16 v[16:31], v[208:211], v[80:87], v4
    buffer_load_dwordx4 v[232:235], v3, s[32:35], s64 offen offset:2048 sc1
    buffer_load_dwordx4 v[236:239], v3, s[32:35], s64 offen offset:3072 sc1
    v_exp_f32 v104, v104
    v_exp_f32 v105, v105
    v_exp_f32 v106, v106
    v_exp_f32 v107, v107
    v_smfmac_f32_32x32x32_bf16 v[16:31], v[212:215], v[88:95], v4
    v_exp_f32 v108, v108
    v_exp_f32 v109, v109
    v_exp_f32 v110, v110
    v_exp_f32 v111, v111
    v_mfma_f32_32x32x16_bf16 v[128:143], v[176:179], v[168:171], 0
    v_exp_f32 v112, v112
    v_exp_f32 v113, v113
    v_exp_f32 v114, v114
    v_exp_f32 v115, v115
    v_mfma_f32_32x32x16_bf16 v[128:143], v[180:183], v[172:175], v[128:143]
    v_exp_f32 v116, v116
    v_exp_f32 v117, v117
    v_exp_f32 v118, v118
    v_exp_f32 v119, v119
    v_smfmac_f32_32x32x32_bf16 v[32:47], v[208:211], v[96:103], v4
    v_exp_f32 v120, v120
    v_exp_f32 v121, v121
    v_exp_f32 v122, v122
    v_exp_f32 v123, v123
    v_smfmac_f32_32x32x32_bf16 v[32:47], v[212:215], v[104:111], v4
    v_exp_f32 v124, v124
    v_exp_f32 v125, v125
    v_exp_f32 v126, v126
    v_exp_f32 v127, v127
    s_waitcnt vmcnt(8)
    v_mfma_f32_32x32x16_bf16 v[80:95], v[184:187], v[144:147], 0
    v_exp_f32 v128, v128
    v_exp_f32 v129, v129
    v_exp_f32 v130, v130
    v_exp_f32 v131, v131
    v_mfma_f32_32x32x16_bf16 v[80:95], v[188:191], v[148:151], v[80:95]
    v_exp_f32 v132, v132
    v_exp_f32 v133, v133
    v_exp_f32 v134, v134
    v_exp_f32 v135, v135
    v_smfmac_f32_32x32x32_bf16 v[48:63], v[208:211], v[112:119], v4
    s_add_u32 s64, s64, 16384
    s_and_b32 s64, s64, 0x3ffff
    buffer_load_dwordx4 v[176:179], v3, s[32:35], s64 offen sc1
    buffer_load_dwordx4 v[180:183], v3, s[32:35], s64 offen offset:1024 sc1
    v_exp_f32 v136, v136
    v_exp_f32 v137, v137
    v_exp_f32 v138, v138
    v_exp_f32 v139, v139
    v_smfmac_f32_32x32x32_bf16 v[48:63], v[212:215], v[120:127], v4
    v_exp_f32 v140, v140
    v_exp_f32 v141, v141
    v_exp_f32 v142, v142
    v_exp_f32 v143, v143
    s_setprio 1
    s_cmp_lg_u32 s66, s68
    s_cbranch_scc1 L_loop
    buffer_wbl2 sc1
    s_branch L_loop
L_last:
    v_mfma_f32_32x32x16_bf16 v[96:111], v[200:203], v[152:155], 0
    ds_read_b32 v250, v254
    v_exp_f32 v80, v80
    v_exp_f32 v81, v81
    v_exp_f32 v82, v82
    v_exp_f32 v83, v83
    v_mfma_f32_32x32x16_bf16 v[96:111], v[204:207], v[156:159], v[96:111]
    v_exp_f32 v84, v84
    v_exp_f32 v85, v85
    v_exp_f32 v86, v86
    v_exp_f32 v87, v87
    v_smfmac_f32_32x32x32_bf16 v[64:79], v[224:227], v[128:135], v4
    v_exp_f32 v88, v88
    v_exp_f32 v89, v89
    v_exp_f32 v90, v90
    v_exp_f32 v91, v91
    v_smfmac_f32_32x32x32_bf16 v[64:79], v[228:231], v[136:143], v4
    v_exp_f32 v92, v92
    v_exp_f32 v93, v93
    v_exp_f32 v94, v94
    v_exp_f32 v95, v95
    s_waitcnt lgkmcnt(0)
    v_cmp_gt_u32 vcc, s65, v250
    s_cbranch_vccnz L_busy
L_free:
    v_mfma_f32_32x32x16_bf16 v[112:127], v[200:203], v[160:163], 0
    v_exp_f32 v96, v96
    v_exp_f32 v97, v97
    v_exp_f32 v98, v98
    v_exp_f32 v99, v99
    v_mfma_f32_32x32x16_bf16 v[112:127], v[204:207], v[164:167], v[112:127]
    v_exp_f32 v100, v100
    v_exp_f32 v101, v101
    v_exp_f32 v102, v102
    v_exp_f32 v103, v103
    v_smfmac_f32_32x32x32_bf16 v[16:31], v[232:235], v[80:87], v4
    s_lshl_b32 s61, s56, 2
    s_add_u32 s61, s61, s53
    s_lshl_b32 s61, s61, 1
    s_add_u32 s61, s61, s54
    s_lshl_b32 s61, s61, 4
    s_add_u32 s61, s61, s55
    s_lshl_b32 s61, s61, 11
    s_add_u32 s61, s61, 8388608
    s_mov_b32 s10, 0x07060302
    s_mov_b32 s11, 0x07060100
    v_mov_b32 v251, 15
    v_exp_f32 v104, v104
    v_exp_f32 v105, v105
    v_exp_f32 v106, v106
    v_exp_f32 v107, v107
    v_smfmac_f32_32x32x32_bf16 v[16:31], v[236:239], v[88:95], v4
    v_exp_f32 v108, v108
    v_exp_f32 v109, v109
    v_exp_f32 v110, v110
    v_exp_f32 v111, v111
    v_mfma_f32_32x32x16_bf16 v[128:143], v[200:203], v[168:171], 0
    v_exp_f32 v112, v112
    v_exp_f32 v113, v113
    v_exp_f32 v114, v114
    v_exp_f32 v115, v115
    v_mfma_f32_32x32x16_bf16 v[128:143], v[204:207], v[172:175], v[128:143]
    v_exp_f32 v116, v116
    v_exp_f32 v117, v117
    v_exp_f32 v118, v118
    v_exp_f32 v119, v119
    v_smfmac_f32_32x32x32_bf16 v[32:47], v[232:235], v[96:103], v4
    ds_write_b128 v12, v[16:19] offset:0
    ds_write_b128 v12, v[20:23] offset:1024
    ds_write_b128 v12, v[24:27] offset:2048
    ds_write_b128 v12, v[28:31] offset:3072
    v_exp_f32 v120, v120
    v_exp_f32 v121, v121
    v_exp_f32 v122, v122
    v_exp_f32 v123, v123
    v_smfmac_f32_32x32x32_bf16 v[32:47], v[236:239], v[104:111], v4
    v_exp_f32 v124, v124
    v_exp_f32 v125, v125
    v_exp_f32 v126, v126
    v_exp_f32 v127, v127
    v_smfmac_f32_32x32x32_bf16 v[48:63], v[232:235], v[112:119], v4
    v_exp_f32 v128, v128
    v_exp_f32 v129, v129
    v_exp_f32 v130, v130
    v_exp_f32 v131, v131
    v_smfmac_f32_32x32x32_bf16 v[48:63], v[236:239], v[120:127], v4
    v_exp_f32 v132, v132
    v_exp_f32 v133, v133
    v_exp_f32 v134, v134
    v_exp_f32 v135, v135
    ds_write_b128 v13, v[32:35] offset:0
    ds_write_b128 v13, v[36:39] offset:1024
    ds_write_b128 v13, v[40:43] offset:2048
    ds_write_b128 v13, v[44:47] offset:3072
    v_smfmac_f32_32x32x32_bf16 v[64:79], v[232:235], v[128:135], v4
    v_exp_f32 v136, v136
    v_exp_f32 v137, v137
    v_exp_f32 v138, v138
    v_exp_f32 v139, v139
    ds_write_b128 v14, v[48:51] offset:0
    ds_write_b128 v14, v[52:55] offset:1024
    ds_write_b128 v14, v[56:59] offset:2048
    ds_write_b128 v14, v[60:63] offset:3072
    ds_write_b32 v252, v251
    v_exp_f32 v140, v140
    v_exp_f32 v141, v141
    v_exp_f32 v142, v142
    v_exp_f32 v143, v143
    ds_read_b32 v250, v253
    v_mov_b32 v144, 0
    v_smfmac_f32_32x32x32_bf16 v[64:79], v[236:239], v[136:143], v4
L_rd:
    ds_read_b128 v[80:83], v11 offset:0
    ds_read_b128 v[84:87], v11 offset:1024
    ds_read_b128 v[88:91], v11 offset:2048
    ds_read_b128 v[92:95], v11 offset:3072
    ds_read_b128 v[96:99], v11 offset:4096
    ds_read_b128 v[100:103], v11 offset:5120
    ds_read_b128 v[104:107], v11 offset:6144
    ds_read_b128 v[108:111], v11 offset:7168
    ds_read_b128 v[112:115], v11 offset:8192
    ds_read_b128 v[116:119], v11 offset:9216
    ds_read_b128 v[120:123], v11 offset:10240
    ds_read_b128 v[124:127], v11 offset:11264
    v_mov_b32 v145, 0
    v_mov_b32 v147, 0x5d800000
    s_waitcnt lgkmcnt(12)
    v_cmp_gt_u32 vcc, 15, v250
    s_cbranch_vccnz L_rwait
    s_waitcnt lgkmcnt(4)
    v_pk_add_f32 v[80:81], v[80:81], v[96:97]
    v_pk_add_f32 v[82:83], v[82:83], v[98:99]
    v_pk_add_f32 v[84:85], v[84:85], v[100:101]
    v_pk_add_f32 v[86:87], v[86:87], v[102:103]
    v_pk_add_f32 v[88:89], v[88:89], v[104:105]
    v_pk_add_f32 v[90:91], v[90:91], v[106:107]
    v_pk_add_f32 v[92:93], v[92:93], v[108:109]
    v_pk_add_f32 v[94:95], v[94:95], v[110:111]
    s_waitcnt lgkmcnt(0)
    v_pk_add_f32 v[80:81], v[80:81], v[112:113]
    v_pk_add_f32 v[82:83], v[82:83], v[114:115]
    v_pk_add_f32 v[84:85], v[84:85], v[116:117]
    v_pk_add_f32 v[86:87], v[86:87], v[118:119]
    v_pk_add_f32 v[88:89], v[88:89], v[120:121]
    v_pk_add_f32 v[90:91], v[90:91], v[122:123]
    v_pk_add_f32 v[92:93], v[92:93], v[124:125]
    v_pk_add_f32 v[94:95], v[94:95], v[126:127]
L_add:
    v_pk_add_f32 v[76:77], v[76:77], v[92:93]
    v_pk_add_f32 v[78:79], v[78:79], v[94:95]
    v_mov_b32 v1, v76
    v_mov_b32 v146, v76
    v_pk_add_f32 v[64:65], v[64:65], v[80:81]
    v_pk_add_f32 v[66:67], v[66:67], v[82:83]
    v_permlane32_swap_b32 v1, v146
    v_pk_add_f32 v[68:69], v[68:69], v[84:85]
    v_pk_add_f32 v[70:71], v[70:71], v[86:87]
    v_rcp_f32 v1, v146
    v_pk_add_f32 v[72:73], v[72:73], v[88:89]
    v_pk_add_f32 v[74:75], v[74:75], v[90:91]
    v_mul_f32 v148, v1, v6
    v_pk_fma_f32 v[144:145], v[64:65], 0, v[144:145]
    v_pk_fma_f32 v[144:145], v[66:67], 0, v[144:145]
    v_pk_fma_f32 v[144:145], v[68:69], 0, v[144:145]
    v_pk_fma_f32 v[144:145], v[70:71], 0, v[144:145]
    v_pk_fma_f32 v[144:145], v[72:73], 0, v[144:145]
    v_pk_fma_f32 v[144:145], v[74:75], 0, v[144:145]
    v_pk_fma_f32 v[144:145], v[76:77], 0, v[144:145]
    v_pk_fma_f32 v[144:145], v[78:79], 0, v[144:145]
    v_pk_mul_f32 v[64:65], v[64:65], v[148:149] op_sel_hi:[1,0]
    v_pk_mul_f32 v[66:67], v[66:67], v[148:149] op_sel_hi:[1,0]
    v_pk_mul_f32 v[68:69], v[68:69], v[148:149] op_sel_hi:[1,0]
    v_pk_mul_f32 v[70:71], v[70:71], v[148:149] op_sel_hi:[1,0]
    v_pk_mul_f32 v[72:73], v[72:73], v[148:149] op_sel_hi:[1,0]
    v_pk_mul_f32 v[74:75], v[74:75], v[148:149] op_sel_hi:[1,0]
    v_pk_mul_f32 v[76:77], v[76:77], v[148:149] op_sel_hi:[1,0]
    v_pk_mul_f32 v[78:79], v[78:79], v[148:149] op_sel_hi:[1,0]
    v_add_f32 v144, v144, v145
    v_add_f32 v144, v144, v146
    v_cvt_pk_bf16_f32 v64, v64, v65
    v_cvt_pk_bf16_f32 v65, v66, v67
    v_cvt_pk_bf16_f32 v66, v68, v69
    v_cvt_pk_bf16_f32 v67, v70, v71
    v_cvt_pk_bf16_f32 v68, v72, v73
    v_cvt_pk_bf16_f32 v69, v74, v75
    v_cvt_pk_bf16_f32 v70, v76, v77
    v_cvt_pk_bf16_f32 v71, v78, v79
    v_cmp_nle_f32 vcc, 0x21800000, v144
    v_cmp_nge_f32 s[22:23], v147, v144
    v_permlane32_swap_b32 v70, v71
    s_or_b64 vcc, vcc, s[22:23]
    s_cselect_b32 s63, 1, 0
    v_perm_b32 v71, v5, v67, s10
    v_perm_b32 v67, v5, v67, s11
    s_cmp_gt_u32 s63, s67
    s_cbranch_scc1 L_fallback
    buffer_store_dwordx4 v[64:67], v3, s[36:39], s61 offen sc1
    buffer_store_dwordx4 v[68:71], v3, s[36:39], s61 offen offset:1024 sc1
    s_cmp_eq_u32 s54, 1
    s_cbranch_scc1 L_fin
    s_cmp_lt_u32 s2, 224
    s_cbranch_scc1 L_proj
    v_mov_b32 v251, 18
    ds_write_b32 v252, v251
L_fin:
    s_endpgm
L_farkv:
    buffer_store_dwordx4 v[176:179], v3, s[32:35], s64 offen offset:0 sc1
    buffer_store_dwordx4 v[180:183], v3, s[32:35], s64 offen offset:1024 sc1
    buffer_store_dwordx4 v[208:211], v3, s[32:35], s64 offen offset:2048 sc1
    buffer_store_dwordx4 v[212:215], v3, s[32:35], s64 offen offset:3072 sc1
    s_branch L_kvdone
L_farfl:
    buffer_store_dword v5, off, s[36:39], s61 sc1
    s_branch L_fldone
L_rwait:
    s_mov_b32 s69, 2097152
L_lw4:
    ds_read_b32 v250, v253
    s_sub_u32 s69, s69, 1
    s_waitcnt lgkmcnt(0)
    v_cmp_gt_u32 vcc, 15, v250
    s_cbranch_vccz L_lx4
    s_cbranch_scc0 L_lw4
L_lx4:
    v_mov_b32 v250, 15
    s_branch L_rd
L_busy:
    s_mov_b32 s69, 2097152
L_lw5:
    ds_read_b32 v250, v254
    s_sub_u32 s69, s69, 1
    s_waitcnt lgkmcnt(0)
    v_cmp_gt_u32 vcc, s65, v250
    s_cbranch_vccz L_lx5
    s_cbranch_scc0 L_lw5
L_lx5:
    s_branch L_free
L_proj:
    v_mov_b32 v251, 16
    ds_write_b32 v252, v251
    s_setprio 3
    s_lshr_b32 s71, s2, 3
    s_mul_i32 s61, s71, 37
    s_lshr_b32 s61, s61, 8
    s_and_b32 s62, s2, 7
    s_lshl_b32 s62, s62, 2
    s_add_u32 s48, s61, s62
    s_mul_i32 s61, s61, 7
    s_sub_u32 s71, s71, s61
    s_lshl_b32 s71, s71, 7
    s_and_b32 s22, s53, 1
    s_lshr_b32 s23, s53, 1
    s_lshl_b32 s48, s48, 1
    s_add_u32 s48, s48, s22
    s_lshl_b32 s62, s48, 2
    s_add_u32 s62, s62, s23
    s_lshl_b32 s62, s62, 14
    s_add_u32 s62, s62, 8388608
    s_add_u32 s24, s20, s62
    s_addc_u32 s25, s21, 0
    s_mov_b32 s26, 16384
    s_cmp_eq_u32 s23, 0
    s_cselect_b32 s28, s8, s14
    s_cselect_b32 s29, s9, s15
    s_mov_b32 s30, 401408
    s_mov_b32 s40, s18
    s_mov_b32 s41, s19
    s_mov_b32 s42, 1835008
    s_mov_b32 s43, 0x00020000
    s_mov_b32 s12, 0xffff
    s_mov_b32 s47, 0
    s_mov_b32 s66, 0
    v_lshrrev_b32 v11, 3, v2
    v_and_b32 v12, 7, v2
    v_bfe_u32 v13, v2, 4, 1
    v_lshlrev_b32 v8, 11, v12
    v_add_u32 v8, 2044, v8
    s_xor_b32 s61, s22, 1
    s_lshl_b32 s61, s61, 1
    s_add_u32 s61, s61, s23
    s_mul_i32 m0, s61, 28672
    s_cmp_eq_u32 s22, 0
    s_cselect_b32 s13, 0x0e, 0xf1
    s_mov_b32 s61, s71
    s_mov_b32 s58, 4096
    s_mov_b32 s59, 8192
    s_mov_b32 s60, 12288
    v_lshrrev_b32 v241, 3, v2
    v_lshrrev_b32 v243, 2, v2
    v_and_b32 v242, 7, v2
    v_and_b32 v243, 4, v243
    v_xor_b32 v242, v242, v243
    v_mul_u32_u24 v240, 896, v241
    v_lshl_add_u32 v240, v242, 4, v240
    v_add_u32 v241, 6144, v240
    v_add_u32 v242, 12288, v240
    v_add_u32 v243, 18432, v240
    s_mov_b32 s69, 2097152
L_lw6:
    ds_read_b32 v250, v253
    s_sub_u32 s69, s69, 1
    s_waitcnt lgkmcnt(0)
    v_cmp_gt_u32 vcc, 16, v250
    s_cbranch_vccz L_lx6
    s_cbranch_scc0 L_lw6
L_lx6:
L_wo:
    s_bitcmp1_b32 s13, s66
    s_cselect_b32 s62, 25088, 0
    s_add_u32 s62, s62, s61
    buffer_load_dwordx4 v240, s[28:31], s62 offen offset:0 lds
    buffer_load_dwordx4 v241, s[28:31], s62 offen offset:1024 lds
    buffer_load_dwordx4 v242, s[28:31], s62 offen offset:2048 lds
    s_mov_b32 exec_hi, 0
    buffer_load_dwordx4 v243, s[28:31], s62 offen offset:3072 lds
    s_mov_b32 exec_hi, -1
    s_add_u32 s61, s61, 50176
    s_waitcnt vmcnt(4)
    s_add_u32 m0, m0, 3584
    s_add_u32 s66, s66, 1
    s_cmp_lt_u32 s66, 8
    s_cbranch_scc1 L_wo
    v_lshrrev_b32 v12, 5, v2
    v_bfe_u32 v9, v2, 2, 2
    v_lshl_add_u32 v15, v12, 1, v9
    v_add_u32 v15, 24, v15
    v_cmp_gt_u32 vcc, 2, v9
    v_lshl_add_u32 v14, v12, 2, 11
    v_lshl_add_u32 v9, v12, 2, v9
    v_cndmask_b32 v15, v14, v15, vcc
    v_and_b32 v14, 3, v2
    v_lshlrev_b32 v14, 3, v14
    v_lshl_add_u32 v14, v13, 5, v14
    s_mul_i32 s62, s23, 28672
    s_add_u32 s62, s62, 57344
    v_add_u32 v14, s62, v14
    s_waitcnt vmcnt(0)
    v_lshl_add_u32 v240, v9, 7, v14
    v_lshl_add_u32 v242, v15, 7, v14
    v_bfe_u32 v9, v9, 1, 1
    v_bfe_u32 v15, v15, 1, 1
    v_lshl_add_u32 v240, v9, 6, v240
    v_lshl_add_u32 v242, v15, 6, v242
    v_xor_b32 v241, 64, v240
    v_xor_b32 v243, 64, v242
    v_mov_b32 v251, 17
    ds_write_b32 v252, v251
    v_and_b32 v13, 31, v2
    v_mul_u32_u24 v13, 272, v13
    s_mul_i32 s62, s53, 8704
    s_add_u32 s62, s62, 57344
    v_lshl_add_u32 v12, v12, 4, v13
    v_add_u32 v12, s62, v12
    s_lshl_b32 s62, s23, 4
    v_add_u32 v14, s62, v11
    v_and_b32 v15, 7, v2
    v_mul_u32_u24 v13, 272, v14
    s_mul_i32 s62, s22, 8704
    s_add_u32 s62, s62, 57344
    v_lshl_add_u32 v13, v15, 5, v13
    v_add_u32 v13, s62, v13
    s_lshl_b32 s62, s48, 5
    v_add_u32 v14, s62, v14
    v_mul_u32_u24 v14, 896, v14
    v_lshl_add_u32 v14, v15, 4, v14
    v_add_u32 v15, 7168, v14
    s_xor_b32 s62, s53, 2
    s_lshl_b32 s62, s62, 8
    s_add_u32 s62, s62, 155648
    v_mov_b32 v9, s62
    v_mov_b32 v144, 0
    v_mov_b32 v145, 0
    v_mov_b32 v146, 0
    v_mov_b32 v147, 0
    v_mov_b32 v148, 0
    v_mov_b32 v149, 0
    v_mov_b32 v150, 0
    v_mov_b32 v151, 0
    v_mov_b32 v152, 0
    v_mov_b32 v153, 0
    v_mov_b32 v154, 0
    v_mov_b32 v155, 0
    v_mov_b32 v156, 0
    v_mov_b32 v157, 0
    v_mov_b32 v158, 0
    v_mov_b32 v159, 0
    v_mov_b32 v160, 0
    v_mov_b32 v161, 0
    v_mov_b32 v162, 0
    v_mov_b32 v163, 0
    v_mov_b32 v164, 0
    v_mov_b32 v165, 0
    v_mov_b32 v166, 0
    v_mov_b32 v167, 0
    v_mov_b32 v168, 0
    v_mov_b32 v169, 0
    v_mov_b32 v170, 0
    v_mov_b32 v171, 0
    v_mov_b32 v172, 0
    v_mov_b32 v173, 0
    v_mov_b32 v174, 0
    v_mov_b32 v175, 0
    s_mov_b32 s69, 2097152
L_lw7:
    ds_read_b32 v250, v253
    s_sub_u32 s69, s69, 1
    s_waitcnt lgkmcnt(0)
    v_cmp_gt_u32 vcc, 17, v250
    s_cbranch_vccz L_lx7
    s_cbranch_scc0 L_lw7
L_lx7:
L_phase:
    buffer_load_dword v7, v8, s[24:27], 0 offen sc1
    ds_read_b64_tr_b16 v[16:17], v240 offset:0
    ds_read_b64_tr_b16 v[18:19], v240 offset:1024
    ds_read_b64_tr_b16 v[20:21], v241 offset:0
    ds_read_b64_tr_b16 v[22:23], v241 offset:1024
    ds_read_b64_tr_b16 v[24:25], v240 offset:2048
    ds_read_b64_tr_b16 v[26:27], v242 offset:0
    ds_read_b64_tr_b16 v[28:29], v241 offset:2048
    ds_read_b64_tr_b16 v[30:31], v243 offset:0
    s_waitcnt lgkmcnt(7)
    ds_read_b64_tr_b16 v[32:33], v240 offset:3584
    ds_read_b64_tr_b16 v[34:35], v240 offset:4608
    ds_read_b64_tr_b16 v[36:37], v241 offset:3584
    ds_read_b64_tr_b16 v[38:39], v241 offset:4608
    ds_read_b64_tr_b16 v[40:41], v240 offset:5632
    ds_read_b64_tr_b16 v[42:43], v242 offset:3584
    ds_read_b64_tr_b16 v[44:45], v241 offset:5632
    ds_read_b64_tr_b16 v[46:47], v243 offset:3584
    s_waitcnt lgkmcnt(7)
    ds_read_b64_tr_b16 v[48:49], v240 offset:7168
    ds_read_b64_tr_b16 v[50:51], v240 offset:8192
    ds_read_b64_tr_b16 v[52:53], v241 offset:7168
    ds_read_b64_tr_b16 v[54:55], v241 offset:8192
    ds_read_b64_tr_b16 v[56:57], v240 offset:9216
    ds_read_b64_tr_b16 v[58:59], v242 offset:7168
    ds_read_b64_tr_b16 v[60:61], v241 offset:9216
    ds_read_b64_tr_b16 v[62:63], v243 offset:7168
    s_waitcnt lgkmcnt(7)
    ds_read_b64_tr_b16 v[64:65], v240 offset:10752
    ds_read_b64_tr_b16 v[66:67], v240 offset:11776
    ds_read_b64_tr_b16 v[68:69], v241 offset:10752
    ds_read_b64_tr_b16 v[70:71], v241 offset:11776
    ds_read_b64_tr_b16 v[72:73], v240 offset:12800
    ds_read_b64_tr_b16 v[74:75], v242 offset:10752
    ds_read_b64_tr_b16 v[76:77], v241 offset:12800
    ds_read_b64_tr_b16 v[78:79], v243 offset:10752
    s_waitcnt lgkmcnt(7)
    ds_read_b64_tr_b16 v[80:81], v240 offset:14336
    ds_read_b64_tr_b16 v[82:83], v240 offset:15360
    ds_read_b64_tr_b16 v[84:85], v241 offset:14336
    ds_read_b64_tr_b16 v[86:87], v241 offset:15360
    ds_read_b64_tr_b16 v[88:89], v240 offset:16384
    ds_read_b64_tr_b16 v[90:91], v242 offset:14336
    ds_read_b64_tr_b16 v[92:93], v241 offset:16384
    ds_read_b64_tr_b16 v[94:95], v243 offset:14336
    s_waitcnt lgkmcnt(7)
    ds_read_b64_tr_b16 v[96:97], v240 offset:17920
    ds_read_b64_tr_b16 v[98:99], v240 offset:18944
    ds_read_b64_tr_b16 v[100:101], v241 offset:17920
    ds_read_b64_tr_b16 v[102:103], v241 offset:18944
    ds_read_b64_tr_b16 v[104:105], v240 offset:19968
    ds_read_b64_tr_b16 v[106:107], v242 offset:17920
    ds_read_b64_tr_b16 v[108:109], v241 offset:19968
    ds_read_b64_tr_b16 v[110:111], v243 offset:17920
    s_waitcnt lgkmcnt(7)
    ds_read_b64_tr_b16 v[112:113], v240 offset:21504
    ds_read_b64_tr_b16 v[114:115], v240 offset:22528
    ds_read_b64_tr_b16 v[116:117], v241 offset:21504
    ds_read_b64_tr_b16 v[118:119], v241 offset:22528
    ds_read_b64_tr_b16 v[120:121], v240 offset:23552
    ds_read_b64_tr_b16 v[122:123], v242 offset:21504
    ds_read_b64_tr_b16 v[124:125], v241 offset:23552
    ds_read_b64_tr_b16 v[126:127], v243 offset:21504
    s_waitcnt lgkmcnt(7)
    ds_read_b64_tr_b16 v[128:129], v240 offset:25088
    ds_read_b64_tr_b16 v[130:131], v240 offset:26112
    ds_read_b64_tr_b16 v[132:133], v241 offset:25088
    ds_read_b64_tr_b16 v[134:135], v241 offset:26112
    ds_read_b64_tr_b16 v[136:137], v240 offset:27136
    ds_read_b64_tr_b16 v[138:139], v242 offset:25088
    ds_read_b64_tr_b16 v[140:141], v241 offset:27136
    ds_read_b64_tr_b16 v[142:143], v243 offset:25088
    v_mov_b32 v251, 18
    ds_write_b32 v252, v251
    s_setprio 0
    s_mov_b32 s69, 2097152
L_lw8:
    ds_read_b32 v250, v253
    s_sub_u32 s69, s69, 1
    s_waitcnt lgkmcnt(0)
    v_cmp_gt_u32 vcc, 18, v250
    s_cbranch_vccz L_lx8
    s_cbranch_scc0 L_lw8
L_lx8:
L_p0:
    s_mov_b32 s45, 255
    s_mov_b32 s69, 65536
    s_waitcnt vmcnt(0)
L_iss:
    v_xor_b32 v1, v5, v7
    v_cmp_lt_u32 vcc, s12, v1
    s_and_b32 s62, vcc_lo, s45
    s_bcnt1_i32_b32 s63, s62
    s_cmp_le_u32 s63, 3
    s_cselect_b32 s62, 0, s62
    s_andn2_b32 s46, s45, s62
    s_cbranch_scc0 L_hint
    s_bitcmp1_b32 s46, 0
    s_cbranch_scc0 L_c0
    buffer_load_dwordx4 v[176:179], v3, s[24:27], 0 offen offset:0 sc1
    buffer_load_dwordx4 v[180:183], v3, s[24:27], 0 offen offset:1024 sc1
L_c0:
    s_bitcmp1_b32 s46, 1
    s_cbranch_scc0 L_c1
    buffer_load_dwordx4 v[184:187], v3, s[24:27], 0 offen offset:2048 sc1
    buffer_load_dwordx4 v[188:191], v3, s[24:27], 0 offen offset:3072 sc1
L_c1:
    s_bitcmp1_b32 s46, 2
    s_cbranch_scc0 L_c2
    buffer_load_dwordx4 v[192:195], v3, s[24:27], s58 offen offset:0 sc1
    buffer_load_dwordx4 v[196:199], v3, s[24:27], s58 offen offset:1024 sc1
L_c2:
    s_bitcmp1_b32 s46, 3
    s_cbranch_scc0 L_c3
    buffer_load_dwordx4 v[200:203], v3, s[24:27], s58 offen offset:2048 sc1
    buffer_load_dwordx4 v[204:207], v3, s[24:27], s58 offen offset:3072 sc1
L_c3:
    s_bitcmp1_b32 s46, 4
    s_cbranch_scc0 L_c4
    buffer_load_dwordx4 v[208:211], v3, s[24:27], s59 offen offset:0 sc1
    buffer_load_dwordx4 v[212:215], v3, s[24:27], s59 offen offset:1024 sc1
L_c4:
    s_bitcmp1_b32 s46, 5
    s_cbranch_scc0 L_c5
    buffer_load_dwordx4 v[216:219], v3, s[24:27], s59 offen offset:2048 sc1
    buffer_load_dwordx4 v[220:223], v3, s[24:27], s59 offen offset:3072 sc1
L_c5:
    s_bitcmp1_b32 s46, 6
    s_cbranch_scc0 L_c6
    buffer_load_dwordx4 v[224:227], v3, s[24:27], s60 offen offset:0 sc1
    buffer_load_dwordx4 v[228:231], v3, s[24:27], s60 offen offset:1024 sc1
L_c6:
    s_bitcmp1_b32 s46, 7
    s_cbranch_scc0 L_c7
    buffer_load_dwordx4 v[232:235], v3, s[24:27], s60 offen offset:2048 sc1
    buffer_load_dwordx4 v[236:239], v3, s[24:27], s60 offen offset:3072 sc1
L_c7:
    buffer_load_dword v7, v8, s[24:27], 0 offen sc1
    s_waitcnt vmcnt(1)
L_chk:
    s_bitcmp1_b32 s46, 0
    s_cbranch_scc0 L_n0
    v_bitop3_b32 v1, v179, v183, v5 bitop3:0x7e
    v_and_b32 v179, s12, v179
    v_cmp_lt_u32 vcc, s12, v1
    v_and_b32 v183, s12, v183
    s_cbranch_vccnz L_n0
    s_bitset0_b32 s45, 0
    v_mfma_f32_32x32x16_bf16 v[144:159], v[16:19], v[176:179], v[144:159]
    v_mfma_f32_32x32x16_bf16 v[160:175], v[20:23], v[176:179], v[160:175]
    v_mfma_f32_32x32x16_bf16 v[144:159], v[24:27], v[180:183], v[144:159]
    v_mfma_f32_32x32x16_bf16 v[160:175], v[28:31], v[180:183], v[160:175]
L_n0:
    s_bitcmp1_b32 s46, 1
    s_cbranch_scc0 L_n1
    v_bitop3_b32 v1, v187, v191, v5 bitop3:0x7e
    v_and_b32 v187, s12, v187
    v_cmp_lt_u32 vcc, s12, v1
    v_and_b32 v191, s12, v191
    s_cbranch_vccnz L_n1
    s_bitset0_b32 s45, 1
    v_mfma_f32_32x32x16_bf16 v[144:159], v[32:35], v[184:187], v[144:159]
    v_mfma_f32_32x32x16_bf16 v[160:175], v[36:39], v[184:187], v[160:175]
    v_mfma_f32_32x32x16_bf16 v[144:159], v[40:43], v[188:191], v[144:159]
    v_mfma_f32_32x32x16_bf16 v[160:175], v[44:47], v[188:191], v[160:175]
L_n1:
    s_bitcmp1_b32 s46, 2
    s_cbranch_scc0 L_n2
    v_bitop3_b32 v1, v195, v199, v5 bitop3:0x7e
    v_and_b32 v195, s12, v195
    v_cmp_lt_u32 vcc, s12, v1
    v_and_b32 v199, s12, v199
    s_cbranch_vccnz L_n2
    s_bitset0_b32 s45, 2
    v_mfma_f32_32x32x16_bf16 v[144:159], v[48:51], v[192:195], v[144:159]
    v_mfma_f32_32x32x16_bf16 v[160:175], v[52:55], v[192:195], v[160:175]
    v_mfma_f32_32x32x16_bf16 v[144:159], v[56:59], v[196:199], v[144:159]
    v_mfma_f32_32x32x16_bf16 v[160:175], v[60:63], v[196:199], v[160:175]
L_n2:
    s_bitcmp1_b32 s46, 3
    s_cbranch_scc0 L_n3
    v_bitop3_b32 v1, v203, v207, v5 bitop3:0x7e
    v_and_b32 v203, s12, v203
    v_cmp_lt_u32 vcc, s12, v1
    v_and_b32 v207, s12, v207
    s_cbranch_vccnz L_n3
    s_bitset0_b32 s45, 3
    v_mfma_f32_32x32x16_bf16 v[144:159], v[64:67], v[200:203], v[144:159]
    v_mfma_f32_32x32x16_bf16 v[160:175], v[68:71], v[200:203], v[160:175]
    v_mfma_f32_32x32x16_bf16 v[144:159], v[72:75], v[204:207], v[144:159]
    v_mfma_f32_32x32x16_bf16 v[160:175], v[76:79], v[204:207], v[160:175]
L_n3:
    s_bitcmp1_b32 s46, 4
    s_cbranch_scc0 L_n4
    v_bitop3_b32 v1, v211, v215, v5 bitop3:0x7e
    v_and_b32 v211, s12, v211
    v_cmp_lt_u32 vcc, s12, v1
    v_and_b32 v215, s12, v215
    s_cbranch_vccnz L_n4
    s_bitset0_b32 s45, 4
    v_mfma_f32_32x32x16_bf16 v[144:159], v[80:83], v[208:211], v[144:159]
    v_mfma_f32_32x32x16_bf16 v[160:175], v[84:87], v[208:211], v[160:175]
    v_mfma_f32_32x32x16_bf16 v[144:159], v[88:91], v[212:215], v[144:159]
    v_mfma_f32_32x32x16_bf16 v[160:175], v[92:95], v[212:215], v[160:175]
L_n4:
    s_bitcmp1_b32 s46, 5
    s_cbranch_scc0 L_n5
    v_bitop3_b32 v1, v219, v223, v5 bitop3:0x7e
    v_and_b32 v219, s12, v219
    v_cmp_lt_u32 vcc, s12, v1
    v_and_b32 v223, s12, v223
    s_cbranch_vccnz L_n5
    s_bitset0_b32 s45, 5
    v_mfma_f32_32x32x16_bf16 v[144:159], v[96:99], v[216:219], v[144:159]
    v_mfma_f32_32x32x16_bf16 v[160:175], v[100:103], v[216:219], v[160:175]
    v_mfma_f32_32x32x16_bf16 v[144:159], v[104:107], v[220:223], v[144:159]
    v_mfma_f32_32x32x16_bf16 v[160:175], v[108:111], v[220:223], v[160:175]
L_n5:
    s_bitcmp1_b32 s46, 6
    s_cbranch_scc0 L_n6
    v_bitop3_b32 v1, v227, v231, v5 bitop3:0x7e
    v_and_b32 v227, s12, v227
    v_cmp_lt_u32 vcc, s12, v1
    v_and_b32 v231, s12, v231
    s_cbranch_vccnz L_n6
    s_bitset0_b32 s45, 6
    v_mfma_f32_32x32x16_bf16 v[144:159], v[112:115], v[224:227], v[144:159]
    v_mfma_f32_32x32x16_bf16 v[160:175], v[116:119], v[224:227], v[160:175]
    v_mfma_f32_32x32x16_bf16 v[144:159], v[120:123], v[228:231], v[144:159]
    v_mfma_f32_32x32x16_bf16 v[160:175], v[124:127], v[228:231], v[160:175]
L_n6:
    s_bitcmp1_b32 s46, 7
    s_cbranch_scc0 L_n7
    v_bitop3_b32 v1, v235, v239, v5 bitop3:0x7e
    v_and_b32 v235, s12, v235
    v_cmp_lt_u32 vcc, s12, v1
    v_and_b32 v239, s12, v239
    s_cbranch_vccnz L_n7
    s_bitset0_b32 s45, 7
    v_mfma_f32_32x32x16_bf16 v[144:159], v[128:131], v[232:235], v[144:159]
    v_mfma_f32_32x32x16_bf16 v[160:175], v[132:135], v[232:235], v[160:175]
    v_mfma_f32_32x32x16_bf16 v[144:159], v[136:139], v[236:239], v[144:159]
    v_mfma_f32_32x32x16_bf16 v[160:175], v[140:143], v[236:239], v[160:175]
L_n7:
    s_cmp_eq_u32 s45, 0
    s_cbranch_scc1 L_got
L_nx:
    s_waitcnt vmcnt(0)
L_nx2:
    s_sub_u32 s69, s69, 1
    s_cbranch_scc0 L_iss
L_got:
    s_cmp_eq_u32 s47, 1
    s_cbranch_scc1 L_out
    s_mov_b32 s47, 1
    s_add_u32 s24, s24, 32768
    s_addc_u32 s25, s25, 0
    v_subrev_u32 v240, 57344, v240
    v_subrev_u32 v241, 57344, v241
    v_subrev_u32 v242, 57344, v242
    v_subrev_u32 v243, 57344, v243
    s_waitcnt vmcnt(0)
    s_nop 15
    s_branch L_phase
L_hint:
    buffer_load_dword v7, v8, s[24:27], 0 offen sc1
    s_branch L_nx
L_out:
    v_mov_b32 v251, 20
    s_nop 8
    ds_write_b128 v12, v[144:147] offset:0
    ds_write_b128 v12, v[148:151] offset:32
    ds_write_b128 v12, v[152:155] offset:64
    ds_write_b128 v12, v[156:159] offset:96
    ds_write_b128 v12, v[160:163] offset:128
    ds_write_b128 v12, v[164:167] offset:160
    ds_write_b128 v12, v[168:171] offset:192
    ds_write_b128 v12, v[172:175] offset:224
    ds_write_b32 v252, v251
    s_mov_b32 s69, 2097152
L_lw9:
    ds_read_b32 v250, v9
    s_sub_u32 s69, s69, 1
    s_waitcnt lgkmcnt(0)
    v_cmp_gt_u32 vcc, 20, v250
    s_cbranch_vccz L_lx9
    s_cbranch_scc0 L_lw9
L_lx9:
    ds_read_b128 v[16:19], v13 offset:0
    ds_read_b128 v[20:23], v13 offset:16
    ds_read_b128 v[24:27], v13 offset:17408
    ds_read_b128 v[28:31], v13 offset:17424
    ds_read_b128 v[32:35], v13 offset:2176
    ds_read_b128 v[36:39], v13 offset:2192
    ds_read_b128 v[40:43], v13 offset:19584
    ds_read_b128 v[44:47], v13 offset:19600
    s_or_b32 s61, s2, s52
    s_cbranch_scc1 L_noepoch
    s_mov_b32 s61, 13107212
    s_mov_b64 exec, 1
    buffer_store_dword v5, off, s[36:39], s61 sc1
    s_mov_b64 exec, -1
L_noepoch:
    s_waitcnt lgkmcnt(4)
    v_pk_add_f32 v[16:17], v[16:17], v[24:25]
    v_pk_add_f32 v[18:19], v[18:19], v[26:27]
    v_pk_add_f32 v[20:21], v[20:21], v[28:29]
    v_pk_add_f32 v[22:23], v[22:23], v[30:31]
    v_cvt_pk_bf16_f32 v16, v16, v17
    v_cvt_pk_bf16_f32 v17, v18, v19
    v_cvt_pk_bf16_f32 v18, v20, v21
    v_cvt_pk_bf16_f32 v19, v22, v23
    buffer_store_dwordx4 v[16:19], v14, s[40:43], s71 offen sc1
    s_waitcnt lgkmcnt(0)
    v_pk_add_f32 v[32:33], v[32:33], v[40:41]
    v_pk_add_f32 v[34:35], v[34:35], v[42:43]
    v_pk_add_f32 v[36:37], v[36:37], v[44:45]
    v_pk_add_f32 v[38:39], v[38:39], v[46:47]
    v_cvt_pk_bf16_f32 v32, v32, v33
    v_cvt_pk_bf16_f32 v33, v34, v35
    v_cvt_pk_bf16_f32 v34, v36, v37
    v_cvt_pk_bf16_f32 v35, v38, v39
    buffer_store_dwordx4 v[32:35], v15, s[40:43], s71 offen sc1
L_end:
    s_endpgm
L_fallback:
    s_waitcnt vmcnt(0)
    s_mov_b32 s67, 1
    v_mov_b32 v150, 0xff800000
    s_mov_b32 s66, 15
L_f1:
    s_add_u32 s64, s64, 4096
    s_and_b32 s64, s64, 0x3ffff
    buffer_load_dwordx4 v[176:179], v3, s[32:35], s64 offen sc1
    buffer_load_dwordx4 v[180:183], v3, s[32:35], s64 offen offset:1024 sc1
    s_add_u32 s64, s64, 4096
    s_and_b32 s64, s64, 0x3ffff
    buffer_load_dwordx4 v[184:187], v3, s[32:35], s64 offen sc1
    buffer_load_dwordx4 v[188:191], v3, s[32:35], s64 offen offset:1024 sc1
    s_add_u32 s64, s64, 4096
    s_and_b32 s64, s64, 0x3ffff
    buffer_load_dwordx4 v[192:195], v3, s[32:35], s64 offen sc1
    buffer_load_dwordx4 v[196:199], v3, s[32:35], s64 offen offset:1024 sc1
    s_add_u32 s64, s64, 4096
    s_and_b32 s64, s64, 0x3ffff
    buffer_load_dwordx4 v[200:203], v3, s[32:35], s64 offen sc1
    buffer_load_dwordx4 v[204:207], v3, s[32:35], s64 offen offset:1024 sc1
    s_waitcnt vmcnt(0)
    v_mfma_f32_32x32x16_bf16 v[80:95], v[176:179], v[168:171], 0
    v_mfma_f32_32x32x16_bf16 v[80:95], v[180:183], v[172:175], v[80:95]
    v_mfma_f32_32x32x16_bf16 v[96:111], v[184:187], v[168:171], 0
    v_mfma_f32_32x32x16_bf16 v[96:111], v[188:191], v[172:175], v[96:111]
    v_mfma_f32_32x32x16_bf16 v[112:127], v[192:195], v[168:171], 0
    v_mfma_f32_32x32x16_bf16 v[112:127], v[196:199], v[172:175], v[112:127]
    v_mfma_f32_32x32x16_bf16 v[128:143], v[200:203], v[168:171], 0
    v_mfma_f32_32x32x16_bf16 v[128:143], v[204:207], v[172:175], v[128:143]
    s_nop 15
    v_max3_f32 v150, v150, v80, v81
    v_max3_f32 v150, v150, v82, v83
    v_max3_f32 v150, v150, v84, v85
    v_max3_f32 v150, v150, v86, v87
    v_max3_f32 v150, v150, v88, v89
    v_max3_f32 v150, v150, v90, v91
    v_max3_f32 v150, v150, v92, v93
    v_max3_f32 v150, v150, v94, v95
    v_max3_f32 v150, v150, v96, v97
    v_max3_f32 v150, v150, v98, v99
    v_max3_f32 v150, v150, v100, v101
    v_max3_f32 v150, v150, v102, v103
    v_max3_f32 v150, v150, v104, v105
    v_max3_f32 v150, v150, v106, v107
    v_max3_f32 v150, v150, v108, v109
    v_max3_f32 v150, v150, v110, v111
    v_max3_f32 v150, v150, v112, v113
    v_max3_f32 v150, v150, v114, v115
    v_max3_f32 v150, v150, v116, v117
    v_max3_f32 v150, v150, v118, v119
    v_max3_f32 v150, v150, v120, v121
    v_max3_f32 v150, v150, v122, v123
    v_max3_f32 v150, v150, v124, v125
    v_max3_f32 v150, v150, v126, v127
    v_max3_f32 v150, v150, v128, v129
    v_max3_f32 v150, v150, v130, v131
    v_max3_f32 v150, v150, v132, v133
    v_max3_f32 v150, v150, v134, v135
    v_max3_f32 v150, v150, v136, v137
    v_max3_f32 v150, v150, v138, v139
    v_max3_f32 v150, v150, v140, v141
    v_max3_f32 v150, v150, v142, v143
    s_sub_u32 s66, s66, 1
    s_cbranch_scc0 L_f1
    v_mov_b32 v1, v150
    s_nop 1
    v_permlane32_swap_b32 v1, v150
    s_nop 1
    v_max_f32 v150, v150, v1
    v_mov_b32 v64, 0
    v_mov_b32 v65, 0
    v_mov_b32 v66, 0
    v_mov_b32 v67, 0
    v_mov_b32 v68, 0
    v_mov_b32 v69, 0
    v_mov_b32 v70, 0
    v_mov_b32 v71, 0
    v_mov_b32 v72, 0
    v_mov_b32 v73, 0
    v_mov_b32 v74, 0
    v_mov_b32 v75, 0
    v_mov_b32 v76, 0
    v_mov_b32 v77, 0
    v_mov_b32 v78, 0
    v_mov_b32 v79, 0
    s_mov_b32 s66, 15
L_f2:
    s_add_u32 s64, s64, 4096
    s_and_b32 s64, s64, 0x3ffff
    buffer_load_dwordx4 v[176:179], v3, s[32:35], s64 offen sc1
    buffer_load_dwordx4 v[180:183], v3, s[32:35], s64 offen offset:1024 sc1
    buffer_load_dwordx4 v[208:211], v3, s[32:35], s64 offen offset:2048 sc1
    buffer_load_dwordx4 v[212:215], v3, s[32:35], s64 offen offset:3072 sc1
    s_add_u32 s64, s64, 4096
    s_and_b32 s64, s64, 0x3ffff
    buffer_load_dwordx4 v[184:187], v3, s[32:35], s64 offen sc1
    buffer_load_dwordx4 v[188:191], v3, s[32:35], s64 offen offset:1024 sc1
    buffer_load_dwordx4 v[216:219], v3, s[32:35], s64 offen offset:2048 sc1
    buffer_load_dwordx4 v[220:223], v3, s[32:35], s64 offen offset:3072 sc1
    s_add_u32 s64, s64, 4096
    s_and_b32 s64, s64, 0x3ffff
    buffer_load_dwordx4 v[192:195], v3, s[32:35], s64 offen sc1
    buffer_load_dwordx4 v[196:199], v3, s[32:35], s64 offen offset:1024 sc1
    buffer_load_dwordx4 v[224:227], v3, s[32:35], s64 offen offset:2048 sc1
    buffer_load_dwordx4 v[228:231], v3, s[32:35], s64 offen offset:3072 sc1
    s_add_u32 s64, s64, 4096
    s_and_b32 s64, s64, 0x3ffff
    buffer_load_dwordx4 v[200:203], v3, s[32:35], s64 offen sc1
    buffer_load_dwordx4 v[204:207], v3, s[32:35], s64 offen offset:1024 sc1
    buffer_load_dwordx4 v[232:235], v3, s[32:35], s64 offen offset:2048 sc1
    buffer_load_dwordx4 v[236:239], v3, s[32:35], s64 offen offset:3072 sc1
    s_waitcnt vmcnt(0)
    v_mfma_f32_32x32x16_bf16 v[80:95], v[176:179], v[168:171], 0
    v_mfma_f32_32x32x16_bf16 v[80:95], v[180:183], v[172:175], v[80:95]
    v_mfma_f32_32x32x16_bf16 v[96:111], v[184:187], v[168:171], 0
    v_mfma_f32_32x32x16_bf16 v[96:111], v[188:191], v[172:175], v[96:111]
    v_mfma_f32_32x32x16_bf16 v[112:127], v[192:195], v[168:171], 0
    v_mfma_f32_32x32x16_bf16 v[112:127], v[196:199], v[172:175], v[112:127]
    v_mfma_f32_32x32x16_bf16 v[128:143], v[200:203], v[168:171], 0
    v_mfma_f32_32x32x16_bf16 v[128:143], v[204:207], v[172:175], v[128:143]
    s_nop 15
    v_sub_f32 v80, v80, v150
    v_sub_f32 v81, v81, v150
    v_sub_f32 v82, v82, v150
    v_sub_f32 v83, v83, v150
    v_sub_f32 v84, v84, v150
    v_sub_f32 v85, v85, v150
    v_sub_f32 v86, v86, v150
    v_sub_f32 v87, v87, v150
    v_sub_f32 v88, v88, v150
    v_sub_f32 v89, v89, v150
    v_sub_f32 v90, v90, v150
    v_sub_f32 v91, v91, v150
    v_sub_f32 v92, v92, v150
    v_sub_f32 v93, v93, v150
    v_sub_f32 v94, v94, v150
    v_sub_f32 v95, v95, v150
    v_sub_f32 v96, v96, v150
    v_sub_f32 v97, v97, v150
    v_sub_f32 v98, v98, v150
    v_sub_f32 v99, v99, v150
    v_sub_f32 v100, v100, v150
    v_sub_f32 v101, v101, v150
    v_sub_f32 v102, v102, v150
    v_sub_f32 v103, v103, v150
    v_sub_f32 v104, v104, v150
    v_sub_f32 v105, v105, v150
    v_sub_f32 v106, v106, v150
    v_sub_f32 v107, v107, v150
    v_sub_f32 v108, v108, v150
    v_sub_f32 v109, v109, v150
    v_sub_f32 v110, v110, v150
    v_sub_f32 v111, v111, v150
    v_sub_f32 v112, v112, v150
    v_sub_f32 v113, v113, v150
    v_sub_f32 v114, v114, v150
    v_sub_f32 v115, v115, v150
    v_sub_f32 v116, v116, v150
    v_sub_f32 v117, v117, v150
    v_sub_f32 v118, v118, v150
    v_sub_f32 v119, v119, v150
    v_sub_f32 v120, v120, v150
    v_sub_f32 v121, v121, v150
    v_sub_f32 v122, v122, v150
    v_sub_f32 v123, v123, v150
    v_sub_f32 v124, v124, v150
    v_sub_f32 v125, v125, v150
    v_sub_f32 v126, v126, v150
    v_sub_f32 v127, v127, v150
    v_sub_f32 v128, v128, v150
    v_sub_f32 v129, v129, v150
    v_sub_f32 v130, v130, v150
    v_sub_f32 v131, v131, v150
    v_sub_f32 v132, v132, v150
    v_sub_f32 v133, v133, v150
    v_sub_f32 v134, v134, v150
    v_sub_f32 v135, v135, v150
    v_sub_f32 v136, v136, v150
    v_sub_f32 v137, v137, v150
    v_sub_f32 v138, v138, v150
    v_sub_f32 v139, v139, v150
    v_sub_f32 v140, v140, v150
    v_sub_f32 v141, v141, v150
    v_sub_f32 v142, v142, v150
    v_sub_f32 v143, v143, v150
    v_exp_f32 v80, v80
    v_exp_f32 v81, v81
    v_exp_f32 v82, v82
    v_exp_f32 v83, v83
    v_exp_f32 v84, v84
    v_exp_f32 v85, v85
    v_exp_f32 v86, v86
    v_exp_f32 v87, v87
    v_exp_f32 v88, v88
    v_exp_f32 v89, v89
    v_exp_f32 v90, v90
    v_exp_f32 v91, v91
    v_exp_f32 v92, v92
    v_exp_f32 v93, v93
    v_exp_f32 v94, v94
    v_exp_f32 v95, v95
    v_exp_f32 v96, v96
    v_exp_f32 v97, v97
    v_exp_f32 v98, v98
    v_exp_f32 v99, v99
    v_exp_f32 v100, v100
    v_exp_f32 v101, v101
    v_exp_f32 v102, v102
    v_exp_f32 v103, v103
    v_exp_f32 v104, v104
    v_exp_f32 v105, v105
    v_exp_f32 v106, v106
    v_exp_f32 v107, v107
    v_exp_f32 v108, v108
    v_exp_f32 v109, v109
    v_exp_f32 v110, v110
    v_exp_f32 v111, v111
    v_exp_f32 v112, v112
    v_exp_f32 v113, v113
    v_exp_f32 v114, v114
    v_exp_f32 v115, v115
    v_exp_f32 v116, v116
    v_exp_f32 v117, v117
    v_exp_f32 v118, v118
    v_exp_f32 v119, v119
    v_exp_f32 v120, v120
    v_exp_f32 v121, v121
    v_exp_f32 v122, v122
    v_exp_f32 v123, v123
    v_exp_f32 v124, v124
    v_exp_f32 v125, v125
    v_exp_f32 v126, v126
    v_exp_f32 v127, v127
    v_exp_f32 v128, v128
    v_exp_f32 v129, v129
    v_exp_f32 v130, v130
    v_exp_f32 v131, v131
    v_exp_f32 v132, v132
    v_exp_f32 v133, v133
    v_exp_f32 v134, v134
    v_exp_f32 v135, v135
    v_exp_f32 v136, v136
    v_exp_f32 v137, v137
    v_exp_f32 v138, v138
    v_exp_f32 v139, v139
    v_exp_f32 v140, v140
    v_exp_f32 v141, v141
    v_exp_f32 v142, v142
    v_exp_f32 v143, v143
    s_nop 3
    v_smfmac_f32_32x32x32_bf16 v[64:79], v[208:211], v[80:87], v4
    v_smfmac_f32_32x32x32_bf16 v[64:79], v[212:215], v[88:95], v4
    v_smfmac_f32_32x32x32_bf16 v[64:79], v[216:219], v[96:103], v4
    v_smfmac_f32_32x32x32_bf16 v[64:79], v[220:223], v[104:111], v4
    v_smfmac_f32_32x32x32_bf16 v[64:79], v[224:227], v[112:119], v4
    v_smfmac_f32_32x32x32_bf16 v[64:79], v[228:231], v[120:127], v4
    v_smfmac_f32_32x32x32_bf16 v[64:79], v[232:235], v[128:135], v4
    v_smfmac_f32_32x32x32_bf16 v[64:79], v[236:239], v[136:143], v4
    s_nop 15
    s_sub_u32 s66, s66, 1
    s_cbranch_scc0 L_f2
    v_mov_b32 v144, 0
    v_mov_b32 v145, 0
    v_mov_b32 v80, 0
    v_mov_b32 v81, 0
    v_mov_b32 v82, 0
    v_mov_b32 v83, 0
    v_mov_b32 v84, 0
    v_mov_b32 v85, 0
    v_mov_b32 v86, 0
    v_mov_b32 v87, 0
    v_mov_b32 v88, 0
    v_mov_b32 v89, 0
    v_mov_b32 v90, 0
    v_mov_b32 v91, 0
    v_mov_b32 v92, 0
    v_mov_b32 v93, 0
    v_mov_b32 v94, 0
    v_mov_b32 v95, 0
    s_branch L_add
.section .rodata,"a"
.p2align 6
.amdhsa_kernel gated_mix__softmax_full_mha__mha_block__prompt_kernel
  .amdhsa_next_free_vgpr 256
  .amdhsa_next_free_sgpr 102
  .amdhsa_accum_offset 256
  .amdhsa_group_segment_fixed_size 0
  .amdhsa_kernarg_size 80
  .amdhsa_user_sgpr_count 2
  .amdhsa_user_sgpr_kernarg_segment_ptr 1
  .amdhsa_system_sgpr_workgroup_id_x 1
.end_amdhsa_kernel
```
